```python
import torch

def _softmax(x, axis=-1):
    return torch.softmax(x, dim=axis)
def _gelu(x):
    return torch.nn.functional.gelu(x, approximate="tanh")
def _silu(x):
    return torch.nn.functional.silu(x)
def _sigmoid(x):
    return torch.sigmoid(x)
def _layernorm(x, axis=-1, eps=1e-5):
    m = x.mean(dim=axis, keepdim=True)
    v = x.var(dim=axis, keepdim=True, unbiased=False)
    return (x - m) / torch.sqrt(v + eps)
def _scatter_add(tgt, idx, src, axis=0):
    return tgt.clone().index_add_(axis, idx, src)
def _segment_sum(src, seg, n):
    out = torch.zeros((n,) + src.shape[1:], dtype=src.dtype)
    return out.index_add_(0, seg, src)
def _pad(x, pw):
    flat = tuple(v for pair in reversed(pw) for v in pair)
    return torch.nn.functional.pad(x, flat)

kernel_name = 'gated_mix__ssm_conv_s5__dense_activation_gelu__prompt'

def setup_inputs():

    _w = (lambda a: (lambda t: t.to(torch.bfloat16) if t.is_floating_point() else t)(torch.as_tensor(a)))
    def _A_setup():
        B, S, D = 1, 2048, 448
        P = D
        Lambda_re = -0.5 * (lambda _x: torch.exp(torch.as_tensor(_x)))((lambda *s: torch.randn(*s, dtype=torch.bfloat16) * 0.2)(P))
        Lambda_im = (lambda *s: torch.randn(*s, dtype=torch.bfloat16) * 0.8)(P) * 1.0
        B_re = (lambda *s: torch.randn(*s, dtype=torch.bfloat16) * 0.2)(P, D) * (D ** -0.5)
        B_im = (lambda *s: torch.randn(*s, dtype=torch.bfloat16) * 0.2)(P, D) * (D ** -0.5)
        C_re = (lambda *s: torch.randn(*s, dtype=torch.bfloat16) * 0.2)(D, P) * (P ** -0.5)
        C_im = (lambda *s: torch.randn(*s, dtype=torch.bfloat16) * 0.2)(D, P) * (P ** -0.5)
        log_dt = (lambda *s: torch.randn(*s, dtype=torch.bfloat16) * 0.2)(P) * 0.3 - 2.0
        Dskip = (lambda *s: torch.randn(*s, dtype=torch.bfloat16) * 0.05)(D)
        return {
            "x": _w((lambda *s: torch.randn(*s, dtype=torch.bfloat16) * 0.05)(B, S, D)),
            "Lambda_re": _w(Lambda_re),
            "Lambda_im": _w(Lambda_im),
            "B_re": _w(B_re),
            "B_im": _w(B_im),
            "C_re": _w(C_re),
            "C_im": _w(C_im),
            "log_dt": _w(log_dt),
            "Dskip": _w(Dskip),
        }
    _A_in = _A_setup()

    def _B_setup():
        B, S, D, F = 1, 2048, 448, 1792
        return {
            "x": _w((lambda *s: torch.randn(*s, dtype=torch.bfloat16) * 0.05)(B, S, D)),
            "w1": _w((lambda *s: torch.randn(*s, dtype=torch.bfloat16) * 3.2)(D, F) * (D ** -0.5)),
            "b1": _w((lambda *s: torch.randn(*s, dtype=torch.bfloat16) * 3.2)(F) * 0.01),
            "w2": _w((lambda *s: torch.randn(*s, dtype=torch.bfloat16) * 0.1)(F, D) * (F ** -0.5)),
            "b2": _w((lambda *s: torch.randn(*s, dtype=torch.bfloat16) * 0.2)(D) * 0.01),
        }
    _B_in = _B_setup()

    return {
        "A_x": _A_in["x"],
        "A_Lambda_re": _A_in["Lambda_re"],
        "A_Lambda_im": _A_in["Lambda_im"],
        "A_B_re": _A_in["B_re"],
        "A_B_im": _A_in["B_im"],
        "A_C_re": _A_in["C_re"],
        "A_C_im": _A_in["C_im"],
        "A_log_dt": _A_in["log_dt"],
        "A_Dskip": _A_in["Dskip"],
        "B_x": _B_in["x"],
        "B_w1": _B_in["w1"],
        "B_b1": _B_in["b1"],
        "B_w2": _B_in["w2"],
        "B_b2": _B_in["b2"],
        "gate_w": _w((lambda *s: torch.randn(*s, dtype=torch.bfloat16) * 0.05)(448) * 16.0),
    }

def reference(A_x, A_Lambda_re, A_Lambda_im, A_B_re, A_B_im, A_C_re, A_C_im, A_log_dt, A_Dskip, B_x, B_w1, B_b1, B_w2, B_b2, gate_w):
    def _A_ref(x, Lambda_re, Lambda_im, B_re, B_im, C_re, C_im, log_dt, Dskip):
        Bsz, L, H = x.shape
        Lam = Lambda_re + 1j * Lambda_im
        Bmat = B_re + 1j * B_im
        Cmat = C_re + 1j * C_im
        dt = torch.exp(log_dt)
        Lam_bar = torch.exp(dt * Lam)
        B_bar = ((Lam_bar - 1.0) / Lam)[:, None] * Bmat
        Bu = torch.einsum("bld,pd->blp", x + 0j, B_bar)
        h = torch.zeros_like(Bu[:, 0, :])
        hs = []
        for t in range(L):
            h = Lam_bar[None, :] * h + Bu[:, t, :]
            hs.append(h)
        hseq = torch.stack(hs, 1)
        y = 2.0 * torch.einsum("blp,dp->bld", hseq, Cmat).real + x * Dskip[None, None, :]
        return y

    def _B_ref(x, w1, b1, w2, b2):
        h = torch.einsum("bsd,df->bsf", x, w1) + b1
        h = _gelu(h)
        return torch.einsum("bsf,fd->bsd", h, w2) + b2

    x = A_x
    g = _sigmoid((x * gate_w).sum(-1, keepdims=True))
    a = _A_ref(x, A_Lambda_re, A_Lambda_im, A_B_re, A_B_im, A_C_re, A_C_im, A_log_dt, A_Dskip)
    b = _B_ref(x, B_w1, B_b1, B_w2, B_b2)
    return g * a + (1 - g) * b
```

```asm
; @launch grid=(256,1,1) block=(256,1,1) lds=159744
.amdgcn_target "amdgcn-amd-amdhsa--gfx950"
.text
.globl gated_mix__ssm_conv_s5__dense_activation_gelu__prompt_kernel
.p2align 8
.type gated_mix__ssm_conv_s5__dense_activation_gelu__prompt_kernel,@function
gated_mix__ssm_conv_s5__dense_activation_gelu__prompt_kernel:
    s_cmp_ge_u32 s2, 256
    s_cbranch_scc1 L_end
    s_load_dwordx16 s[64:79], s[0:1], 0
    s_load_dwordx16 s[80:95], s[0:1], 64
    s_load_dwordx2 s[36:37], s[0:1], 136
    s_getpc_b64 s[100:101]
L_pc:
    s_lshr_b32 s96, s2, 3
    s_lshl_b32 s97, s96, 10
    v_lshl_add_u32 v192, v0, 2, s97
    v_min_u32 v192, L_codeend-L_pc-4, v192
    global_load_dword v224, v192, s[100:101]
    v_lshrrev_b32 v3, 6, v0
    v_and_b32 v1, 63, v0
    v_readfirstlane_b32 s5, v3
    s_bitcmp1_b32 s2, 0
    s_cselect_b32 s97, 28, 0
    s_cselect_b32 s98, 28, 28
    s_cmp_ge_u32 s96, s98
    s_cbranch_scc1 L_helper
    s_add_u32 s96, s96, s97
    s_lshr_b32 s3, s96, 3
    s_and_b32 s96, s96, 7
    s_bfe_u32 s4, s2, 0x20001
    s_lshr_b32 s97, s4, 1
    s_xor_b32 s4, s4, s97
    s_lshl_b32 s4, s4, 3
    s_add_u32 s4, s4, s96
    s_add_u32 s63, s3, s4
    s_lshl_b32 s63, s63, 1
    s_mul_i32 s96, s63, 37
    s_lshr_b32 s96, s96, 8
    s_mulk_i32 s96, 7
    s_sub_u32 s63, s63, s96
    s_lshl_b32 s52, s63, 7
    s_lshl_b32 s2, s3, 7
    s_cmp_eq_u32 s5, 0
    s_cselect_b32 s98, s63, s3
    v_lshrrev_b32 v194, 4, v1
    v_and_b32 v192, 7, v1
    v_xor_b32 v192, v192, v194
    v_lshlrev_b32 v192, 4, v192
    v_lshrrev_b32 v193, 3, v1
    v_xor_b32 v194, 64, v192
    s_movk_i32 s97, 896
    v_mad_u32_u24 v16, v193, s97, v192
    v_mad_u32_u24 v195, v193, s97, v194
    v_add_u32 v198, s98, v193
    v_add_u32 v17, 6144, v195
    v_and_b32 v193, 3, v193
    v_and_or_b32 v193, v1, 32, v193
    v_mad_u32_u24 v14, v193, s97, v192
    v_mad_u32_u24 v195, v193, s97, v194
    v_add_u32 v15, 2560, v195
    v_lshlrev_b32 v28, 4, v1
    s_mov_b32 s10, 1835008
    s_mov_b32 s11, 0x20000
    s_mov_b32 s14, 401408
    s_mov_b32 s15, 0x20000
    s_mov_b32 s18, 401408
    s_mov_b32 s19, 0x20000
    s_lshl_b32 s59, s4, 3
    s_add_u32 s59, s59, s5
    s_mulk_i32 s59, 7168
    s_lshl_b32 s60, s3, 2
    s_add_u32 s60, s60, s5
    s_mulk_i32 s60, 14336
    s_mul_i32 s6, s5, 24576
    s_add_u32 s6, s6, 57344
    s_lshl_b32 s62, s5, 11
    s_waitcnt lgkmcnt(0)
    s_mov_b64 s[8:9], s[64:65]
    s_mov_b64 s[12:13], s[70:71]
    s_mov_b64 s[16:17], s[72:73]
    s_add_u32 m0, s62, 0
    s_add_u32 s97, s59, s52
    buffer_load_dwordx4 v14, s[8:11], s97 offen lds
    buffer_load_dwordx4 v15, s[8:11], s97 offen offset:1024 lds
    s_add_u32 m0, s6, 0
    s_add_u32 s96, s60, s52
    buffer_load_dwordx4 v16, s[12:15], s96 offen offset:0 lds
    buffer_load_dwordx4 v17, s[12:15], s96 offen offset:1024 lds
    s_add_u32 m0, s6, 2048
    s_nop 0
    buffer_load_dwordx4 v16, s[16:19], s96 offen offset:0 lds
    buffer_load_dwordx4 v17, s[16:19], s96 offen offset:1024 lds
    v_subrev_u32 v194, 7, v198
    v_min_u32 v198, v198, v194
    v_and_b32 v194, 0x70, v28
    v_lshl_add_u32 v198, v198, 7, v194
    s_cmp_eq_u32 s5, 1
    s_cselect_b64 s[44:45], s[66:67], s[90:91]
    s_cselect_b64 s[48:49], s[68:69], s[90:91]
    s_cmp_eq_u32 s5, 2
    s_cselect_b64 s[44:45], s[78:79], s[44:45]
    s_cselect_b64 s[48:49], s[80:81], s[48:49]
    s_lshl_b32 s98, s5, 8
    s_add_u32 s99, s98, 158080
    s_add_u32 s98, s98, 157952
    s_movk_i32 s46, 896
    s_mov_b32 s47, 0x20000
    s_mov_b32 s51, 0x20000
    s_lshl_b32 s97, s3, 9
    s_cmp_eq_u32 s5, 0
    s_cselect_b64 s[44:45], s[92:93], s[44:45]
    s_cselect_b64 s[48:49], s[86:87], s[48:49]
    s_cselect_b32 m0, 155648, s98
    s_cselect_b32 s50, 3584, s46
    s_cselect_b32 s97, s97, s2
    s_cselect_b32 s99, 157696, s99
    s_cselect_b32 exec_lo, -1, 0xff
    s_cselect_b32 exec_hi, -1, 0
    buffer_load_dwordx4 v198, s[44:47], 0 offen lds
    s_mov_b32 m0, s99
    s_mov_b32 exec_hi, 0
    buffer_load_dwordx4 v28, s[48:51], s97 offen lds
    s_mov_b64 exec, -1
    s_mov_b64 s[28:29], s[84:85]
    s_mov_b32 s30, 1605632
    s_mov_b32 s31, 0x20000
    s_lshr_b32 s98, s5, 1
    s_lshl_b32 s98, s98, 1
    s_and_b32 s99, s4, 0
    s_add_u32 s98, s98, s99
    s_lshl_b32 s98, s98, 1
    s_and_b32 s99, s5, 1
    s_add_u32 s98, s98, s99
    s_lshl_b32 s82, s98, 6
    s_lshl_b32 s61, s3, 9
    s_add_u32 s61, s61, s82
    v_bfe_u32 v192, v1, 2, 2
    v_lshlrev_b32 v192, 6, v192
    v_bfe_u32 v193, v1, 4, 1
    v_lshl_add_u32 v192, v193, 5, v192
    v_and_b32 v193, 3, v1
    v_lshl_add_u32 v192, v193, 3, v192
    v_add_u32 v192, s6, v192
    v_lshrrev_b32 v194, 5, v1
    v_lshl_add_u32 v12, v194, 9, v192
    v_lshl_add_u32 v13, v194, 8, v192
    v_lshrrev_b32 v192, 2, v1
    v_lshlrev_b32 v193, 4, v193
    v_mul_u32_u24 v194, 3584, v192
    v_add_u32 v18, v194, v193
    v_mul_u32_u24 v194, 896, v192
    v_add_u32 v22, v194, v193
    v_add_u32 v19, 56320, v18
    v_add_u32 v23, 13312, v22
    v_add_u32 v20, 112640, v18
    v_add_u32 v24, 26624, v22
    v_add_u32 v21, 168960, v18
    v_add_u32 v25, 39936, v22
    v_add_u32 v26, 12288, v16
    v_add_u32 v27, 12288, v17
    s_add_u32 s53, s52, 128
    s_cmpk_eq_u32 s53, 896
    s_cselect_b32 s53, 0, s53
    s_add_u32 m0, s62, 8192
    s_add_u32 s97, s59, s53
    buffer_load_dwordx4 v14, s[8:11], s97 offen lds
    buffer_load_dwordx4 v15, s[8:11], s97 offen offset:1024 lds
    s_add_u32 s54, s53, 128
    s_cmpk_eq_u32 s54, 896
    s_cselect_b32 s54, 0, s54
    s_add_u32 s55, s54, 128
    s_cmpk_eq_u32 s55, 896
    s_cselect_b32 s55, 0, s55
    s_add_u32 s56, s55, 128
    s_cmpk_eq_u32 s56, 896
    s_cselect_b32 s56, 0, s56
    s_add_u32 s57, s56, 128
    s_cmpk_eq_u32 s57, 896
    s_cselect_b32 s57, 0, s57
    s_add_u32 s58, s57, 128
    s_cmpk_eq_u32 s58, 896
    s_cselect_b32 s58, 0, s58
    s_mov_b64 s[20:21], s[74:75]
    s_mov_b64 s[24:25], s[76:77]
    s_mov_b64 s[32:33], s[88:89]
    s_mov_b64 s[40:41], s[94:95]
    s_mov_b32 s38, 268435456
    s_mov_b32 s39, 0x20000
    s_mov_b32 s22, 401408
    s_mov_b32 s23, 0x20000
    s_mov_b32 s26, 401408
    s_mov_b32 s27, 0x20000
    s_mov_b32 s34, 1605632
    s_mov_b32 s35, 0x20000
    s_mov_b32 s42, 3670016
    s_mov_b32 s43, 0x20000
    v_and_b32 v192, 31, v1
    v_lshrrev_b32 v193, 5, v1
    v_bfe_u32 v194, v1, 1, 3
    v_xor_b32 v194, v193, v194
    v_lshlrev_b32 v194, 4, v194
    v_lshl_add_u32 v4, v192, 7, v194
    v_xor_b32 v5, 32, v4
    v_xor_b32 v6, 64, v4
    v_xor_b32 v7, 96, v4
    v_add_u32 v8, s6, v4
    v_add_u32 v9, s6, v5
    v_add_u32 v10, s6, v6
    v_add_u32 v11, s6, v7
    s_add_u32 s98, s82, 157696
    v_lshl_add_u32 v46, v193, 3, s98
    s_xor_b32 s99, s82, 128
    s_add_u32 s98, s99, 157696
    v_lshl_add_u32 v47, v193, 3, s98
    s_lshl_b32 s98, s82, 6
    s_add_u32 s98, s98, 8192
    v_add_u32 v29, s98, v28
    s_lshl_b32 s98, s99, 6
    s_add_u32 s98, s98, 8192
    v_add_u32 v175, s98, v28
    s_and_b32 s98, s5, 1
    s_lshl_b32 s98, s98, 6
    s_add_u32 s98, s98, 158592
    v_lshl_add_u32 v199, v192, 1, s98
    v_and_b32 v196, 15, v1
    s_lshl_b32 s98, s5, 5
    s_add_u32 s98, s98, 158208
    v_lshl_add_u32 v196, v196, 1, s98
    v_lshrrev_b32 v192, 4, v1
    v_bfe_u32 v193, v1, 1, 3
    v_xor_b32 v193, v193, v192
    v_lshlrev_b32 v193, 4, v193
    v_lshlrev_b32 v192, 4, v192
    v_add_u32 v214, 155648, v192
    v_and_b32 v192, 15, v1
    v_lshl_add_u32 v193, v192, 7, v193
    v_add_u32 v212, s62, v193
    v_xor_b32 v213, 64, v212
    s_lshl_b32 s99, s3, 1
    s_add_u32 s98, s99, s5
    s_mul_i32 s79, s3, 229376
    s_add_u32 s98, s98, 2
    s_cmp_ge_u32 s98, 14
    s_cselect_b32 s90, 14, 0
    s_sub_u32 s98, s98, s90
    s_mov_b32 s72, s98
    s_lshl_b32 s64, s98, 6
    s_add_u32 s64, s64, s79
    s_mul_i32 s68, s98, 28672
    s_add_u32 s68, s68, s2
    s_add_u32 s98, s98, 4
    s_cmp_ge_u32 s98, 14
    s_cselect_b32 s91, 14, 0
    s_sub_u32 s98, s98, s91
    s_mov_b32 s73, s98
    s_lshl_b32 s65, s98, 6
    s_add_u32 s65, s65, s79
    s_mul_i32 s69, s98, 28672
    s_add_u32 s69, s69, s2
    s_add_u32 s98, s98, 4
    s_cmp_ge_u32 s98, 14
    s_cselect_b32 s92, 14, 0
    s_sub_u32 s98, s98, s92
    s_mov_b32 s74, s98
    s_lshl_b32 s66, s98, 6
    s_add_u32 s66, s66, s79
    s_mul_i32 s70, s98, 28672
    s_add_u32 s70, s70, s2
    s_lshr_b32 s98, s5, 1
    s_add_u32 s98, s98, s99
    s_mul_i32 s67, s98, 114688
    s_and_b32 s98, s5, 1
    s_add_u32 s98, s98, s99
    s_lshl_b32 s99, s98, 6
    s_add_u32 s67, s67, s99
    s_mul_i32 s71, s98, 28672
    s_add_u32 s71, s71, s2
    s_mov_b32 s75, 0xc0135761
    s_mov_b32 s76, 0xbdd2d3e8
    s_cmp_lt_u32 s5, 2
    s_cselect_b64 s[48:49], s[20:21], s[24:25]
    s_mov_b32 s50, 401408
    s_lshl_b32 s98, s3, 2
    s_add_u32 s98, s98, s5
    s_lshl_b32 s98, s98, 13
    s_add_u32 s98, s98, 4096
    s_add_u32 s44, s36, s98
    s_addc_u32 s45, s37, 0
    s_movk_i32 s46, 0x2000
    v_lshrrev_b32 v194, 4, v1
    v_lshlrev_b32 v192, 3, v194
    v_sub_u32 v192, s4, v192
    v_lshlrev_b32 v222, 6, v194
    v_add_u32 v222, 157440, v222
    v_sub_u32 v193, 32, v192
    v_and_b32 v194, 0xf0, v28
    v_lshl_add_u32 v2, v193, 8, v194
    v_med3_i32 v192, v192, 0, 8
    v_sub_u32 v193, 8, v192
    v_bfm_b32 v3, v192, v193
    v_lshrrev_b32 v192, 4, v1
    v_lshlrev_b32 v192, 1, v192
    v_and_b32 v193, 7, v1
    v_xor_b32 v192, v192, v193
    v_lshlrev_b32 v192, 4, v192
    v_and_b32 v193, 15, v1
    v_lshl_add_u32 v192, v193, 7, v192
    s_lshl_b32 s98, s5, 12
    s_add_u32 s98, s98, 40960
    v_add_u32 v160, s98, v192
    v_xor_b32 v161, 16, v160
    v_and_b32 v192, 1, v1
    v_lshlrev_b32 v192, 2, v192
    v_bfe_u32 v193, v1, 4, 1
    v_add_u32 v192, v192, v193
    v_bfe_u32 v193, v1, 2, 2
    v_xor_b32 v192, v192, v193
    v_lshlrev_b32 v192, 4, v192
    v_lshl_add_u32 v192, v193, 7, v192
    v_lshrrev_b32 v193, 5, v1
    v_lshl_add_u32 v192, v193, 10, v192
    v_bfe_u32 v193, v1, 1, 1
    v_lshl_add_u32 v192, v193, 3, v192
    v_add_u32 v162, 40960, v192
    v_xor_b32 v163, 64, v162
    v_xor_b32 v164, 32, v162
    v_xor_b32 v165, 96, v162
    v_bfe_u32 v192, v1, 4, 1
    v_lshlrev_b32 v192, 5, v192
    v_lshrrev_b32 v193, 5, v1
    v_lshl_add_u32 v192, v193, 2, v192
    v_bfe_u32 v193, v1, 2, 2
    v_add_u32 v192, v192, v193
    s_lshl_b32 s98, s5, 3
    v_add_u32 v192, s98, v192
    v_and_b32 v193, 3, v1
    v_lshlrev_b32 v193, 8, v193
    v_lshl_add_u32 v192, v192, 2, v193
    v_add_u32 v169, 156672, v192
    v_bfe_u32 v192, v1, 2, 1
    v_lshlrev_b32 v192, 5, v192
    v_bfe_u32 v193, v1, 3, 2
    v_lshl_add_u32 v192, v193, 2, v192
    v_and_b32 v193, 3, v1
    v_add_u32 v192, v192, v193
    v_lshlrev_b32 v192, 2, v192
    v_add_u32 v168, 157184, v192
    s_sub_u32 s98, 31, s4
    s_lshl_b32 s98, s98, 8
    v_lshrrev_b32 v192, 4, v1
    v_lshl_add_u32 v192, v192, 13, v28
    v_add_u32 v171, s98, v192
    v_mov_b32 v215, 0
    buffer_load_dword v221, v215, s[36:39], 0 offen sc1
    s_add_u32 m0, s6, 8192
    s_add_u32 s80, s60, s53
    buffer_load_dwordx4 v16, s[12:15], s80 offen offset:0 lds
    buffer_load_dwordx4 v17, s[12:15], s80 offen offset:1024 lds
    s_add_u32 m0, s6, 10240
    s_nop 0
    buffer_load_dwordx4 v16, s[16:19], s80 offen offset:0 lds
    buffer_load_dwordx4 v17, s[16:19], s80 offen offset:1024 lds
    s_mul_i32 s96, s52, 1792
    s_add_u32 m0, s6, 4096
    s_add_u32 s96, s96, s61
    buffer_load_dwordx4 v18, s[28:31], s96 offen offset:0 lds
    buffer_load_dwordx4 v19, s[28:31], s96 offen offset:1024 lds
    buffer_load_dwordx4 v20, s[28:31], s96 offen offset:2048 lds
    buffer_load_dwordx4 v21, s[28:31], s96 offen offset:3072 lds
    s_add_u32 m0, s62, 16384
    s_add_u32 s97, s59, s54
    buffer_load_dwordx4 v14, s[8:11], s97 offen lds
    buffer_load_dwordx4 v15, s[8:11], s97 offen offset:1024 lds
    s_waitcnt vmcnt(13)
    s_barrier
    ds_read_b128 a[0:3], v4 offset:0
    ds_read_b128 a[4:7], v4 offset:4096
    ds_read_b128 v[48:51], v8 offset:0
    ds_read_b128 v[200:203], v212 offset:0
    ds_read_b128 v[204:207], v214 offset:0
    ds_read_b128 a[8:11], v5 offset:0
    ds_read_b128 a[12:15], v5 offset:4096
    ds_read_b128 v[52:55], v9 offset:0
    ds_read_u16 v218, v196 offset:256
    ds_read_u16 v216, v196
    ds_read_u16 v217, v196 offset:128
    ds_read_u16 v219, v199
    ds_read_u16 v220, v199 offset:128
    ds_read_b64 v[192:193], v46 offset:0
    ds_read_b64 v[194:195], v46 offset:16
    ds_read_b64 v[196:197], v46 offset:32
    ds_read_b64 v[198:199], v46 offset:48
    s_waitcnt lgkmcnt(12)
    v_mfma_f32_16x16x32_bf16 v[208:211], v[200:203], v[204:207], 0
    v_mfma_f32_32x32x16_bf16 v[64:79], a[0:3], v[48:51], 0
    ds_read_b128 v[200:203], v213 offset:0
    ds_read_b128 v[204:207], v214 offset:64
    ds_read_b128 a[16:19], v6 offset:0
    ds_read_b128 a[20:23], v6 offset:4096
    s_waitcnt lgkmcnt(7)
    v_lshlrev_b32 v176, 16, v192
    v_and_b32 v177, 0xffff0000, v192
    v_mfma_f32_32x32x16_bf16 v[80:95], a[4:7], v[48:51], 0
    ds_read_b128 v[56:59], v10 offset:0
    s_add_u32 m0, s6, 16384
    s_add_u32 s80, s60, s54
    buffer_load_dwordx4 v16, s[12:15], s80 offen offset:0 lds
    buffer_load_dwordx4 v17, s[12:15], s80 offen offset:1024 lds
    s_add_u32 m0, s6, 18432
    s_nop 0
    buffer_load_dwordx4 v16, s[16:19], s80 offen offset:0 lds
    buffer_load_dwordx4 v17, s[16:19], s80 offen offset:1024 lds
    v_lshlrev_b32 v178, 16, v193
    v_and_b32 v179, 0xffff0000, v193
    v_mfma_f32_32x32x16_bf16 v[64:79], a[8:11], v[52:55], v[64:79]
    ds_read_b128 a[24:27], v7 offset:0
    ds_read_b128 a[28:31], v7 offset:4096
    s_waitcnt lgkmcnt(9)
    v_lshlrev_b32 v180, 16, v194
    v_and_b32 v181, 0xffff0000, v194
    v_lshlrev_b32 v182, 16, v195
    v_and_b32 v183, 0xffff0000, v195
    v_mfma_f32_32x32x16_bf16 v[80:95], a[12:15], v[52:55], v[80:95]
    ds_read_b128 v[60:63], v11 offset:0
    s_waitcnt lgkmcnt(6)
    v_mfma_f32_16x16x32_bf16 v[208:211], v[200:203], v[204:207], v[208:211]
    s_mul_i32 s96, s53, 1792
    s_add_u32 m0, s6, 12288
    s_add_u32 s96, s96, s61
    buffer_load_dwordx4 v18, s[28:31], s96 offen offset:0 lds
    buffer_load_dwordx4 v19, s[28:31], s96 offen offset:1024 lds
    v_lshlrev_b32 v184, 16, v196
    s_waitcnt lgkmcnt(3)
    v_mfma_f32_32x32x16_bf16 v[64:79], a[16:19], v[56:59], v[64:79]
    s_waitcnt vmcnt(12)
    s_barrier
    ds_read_b128 v[200:203], v212 offset:8192
    ds_read_b128 v[204:207], v214 offset:128
    ds_read_b128 a[32:35], v4 offset:8192
    ds_read_b128 a[36:39], v4 offset:12288
    v_and_b32 v185, 0xffff0000, v196
    v_mfma_f32_32x32x16_bf16 v[80:95], a[20:23], v[56:59], v[80:95]
    ds_read_b128 v[48:51], v8 offset:8192
    buffer_load_dwordx4 v20, s[28:31], s96 offen offset:2048 lds
    buffer_load_dwordx4 v21, s[28:31], s96 offen offset:3072 lds
    s_add_u32 m0, s62, 24576
    s_add_u32 s97, s59, s55
    buffer_load_dwordx4 v14, s[8:11], s97 offen lds
    buffer_load_dwordx4 v15, s[8:11], s97 offen offset:1024 lds
    v_lshlrev_b32 v186, 16, v197
    s_waitcnt lgkmcnt(5)
    v_mfma_f32_32x32x16_bf16 v[64:79], a[24:27], v[60:63], v[64:79]
    ds_read_b128 a[40:43], v5 offset:8192
    ds_read_b128 a[44:47], v5 offset:12288
    v_and_b32 v187, 0xffff0000, v197
    v_lshlrev_b32 v188, 16, v198
    v_and_b32 v189, 0xffff0000, v198
    v_lshlrev_b32 v190, 16, v199
    v_mfma_f32_32x32x16_bf16 v[80:95], a[28:31], v[60:63], v[80:95]
    ds_read_b128 v[52:55], v9 offset:8192
    s_waitcnt lgkmcnt(6)
    v_mfma_f32_16x16x32_bf16 v[208:211], v[200:203], v[204:207], v[208:211]
    s_add_u32 m0, s6, 0
    s_add_u32 s80, s60, s55
    buffer_load_dwordx4 v16, s[12:15], s80 offen offset:0 lds
    buffer_load_dwordx4 v17, s[12:15], s80 offen offset:1024 lds
    v_and_b32 v191, 0xffff0000, v199
    s_waitcnt lgkmcnt(3)
    v_mfma_f32_32x32x16_bf16 v[64:79], a[32:35], v[48:51], v[64:79]
    ds_read_b128 v[200:203], v213 offset:8192
    ds_read_b128 v[204:207], v214 offset:192
    ds_read_b128 a[48:51], v6 offset:8192
    ds_read_b128 a[52:55], v6 offset:12288
    s_waitcnt vmcnt(16)
    ds_read_b64_tr_b16 v[240:241], v12 offset:4096
    ds_read_b64_tr_b16 v[242:243], v12 offset:4352
    v_mfma_f32_32x32x16_bf16 v[80:95], a[36:39], v[48:51], v[80:95]
    ds_read_b128 v[56:59], v10 offset:8192
    s_mul_i32 s79, s4, 7
    s_lshr_b32 s99, s72, 1
    s_add_u32 s99, s99, s79
    s_mulk_i32 s99, 7
    s_add_u32 s99, s99, s3
    s_lshl_b32 s99, s99, 1
    s_and_b32 s98, s5, 1
    s_add_u32 s99, s99, s98
    s_lshl_b32 s72, s99, 12
    s_waitcnt lgkmcnt(7)
    v_mfma_f32_32x32x16_bf16 v[64:79], a[40:43], v[52:55], v[64:79]
    ds_read_b128 a[56:59], v7 offset:8192
    ds_read_b128 a[60:63], v7 offset:12288
    ds_read_b64_tr_b16 v[244:245], v12 offset:5120
    ds_read_b64_tr_b16 v[246:247], v12 offset:5376
    s_add_u32 s72, s72, 1048576
    s_lshl_b32 s90, s99, 7
    v_mfma_f32_32x32x16_bf16 v[80:95], a[44:47], v[52:55], v[80:95]
    ds_read_b128 v[60:63], v11 offset:8192
    s_waitcnt lgkmcnt(10)
    v_mfma_f32_16x16x32_bf16 v[208:211], v[200:203], v[204:207], v[208:211]
    s_add_u32 m0, s6, 2048
    s_nop 0
    buffer_load_dwordx4 v16, s[16:19], s80 offen offset:0 lds
    buffer_load_dwordx4 v17, s[16:19], s80 offen offset:1024 lds
    s_waitcnt lgkmcnt(5)
    v_mfma_f32_32x32x16_bf16 v[64:79], a[48:51], v[56:59], v[64:79]
    s_waitcnt vmcnt(10)
    s_barrier
    ds_read_b128 v[200:203], v212 offset:16384
    ds_read_b128 a[64:67], v4 offset:16384
    s_add_u32 s90, s90, 262144
    s_lshr_b32 s99, s73, 1
    s_add_u32 s99, s99, s79
    s_mulk_i32 s99, 7
    s_add_u32 s99, s99, s3
    v_mfma_f32_32x32x16_bf16 v[80:95], a[52:55], v[56:59], v[80:95]
    ds_read_b128 v[204:207], v214 offset:256
    ds_read_b128 a[68:71], v4 offset:20480
    s_lshl_b32 s99, s99, 1
    s_and_b32 s98, s5, 1
    s_add_u32 s99, s99, s98
    s_lshl_b32 s73, s99, 12
    s_add_u32 s73, s73, 1048576
    s_lshl_b32 s91, s99, 7
    v_mfma_f32_32x32x16_bf16 v[96:111], v[240:243], a[0:3], v[176:191]
    ds_read_b128 v[48:51], v8 offset:16384
    s_mul_i32 s96, s54, 1792
    s_add_u32 m0, s6, 20480
    s_add_u32 s96, s96, s61
    buffer_load_dwordx4 v18, s[28:31], s96 offen offset:0 lds
    s_add_u32 s91, s91, 262144
    s_lshr_b32 s99, s74, 1
    s_add_u32 s99, s99, s79
    s_mulk_i32 s99, 7
    v_mfma_f32_32x32x16_bf16 v[112:127], v[240:243], a[4:7], v[176:191]
    ds_read_b64_tr_b16 v[248:249], v12 offset:6144
    ds_read_b64_tr_b16 v[250:251], v12 offset:6400
    buffer_load_dwordx4 v19, s[28:31], s96 offen offset:1024 lds
    s_add_u32 s99, s99, s3
    s_lshl_b32 s99, s99, 1
    s_and_b32 s98, s5, 1
    s_add_u32 s99, s99, s98
    s_lshl_b32 s74, s99, 12
    s_waitcnt lgkmcnt(7)
    v_mfma_f32_32x32x16_bf16 v[64:79], a[56:59], v[60:63], v[64:79]
    ds_read_b128 a[72:75], v5 offset:16384
    buffer_load_dwordx4 v20, s[28:31], s96 offen offset:2048 lds
    s_add_u32 s74, s74, 1048576
    s_lshl_b32 s92, s99, 7
    s_add_u32 s92, s92, 262144
    s_mov_b32 s81, 2146435072
    s_mov_b32 s77, 0x00003f80
    s_mov_b32 s78, 0x3f800000
    v_mfma_f32_32x32x16_bf16 v[80:95], a[60:63], v[60:63], v[80:95]
    ds_read_b128 a[76:79], v5 offset:20480
    buffer_load_dwordx4 v21, s[28:31], s96 offen offset:3072 lds
    s_add_u32 s98, s79, s3
    s_mulk_i32 s98, 14
    s_and_b32 s99, s5, 1
    s_add_u32 s98, s98, s99
    s_lshl_b32 s93, s98, 7
    s_add_u32 s93, s93, 262144
    s_lshl_b32 s98, s98, 1
    v_mfma_f32_32x32x16_bf16 v[96:111], v[244:247], a[8:11], v[96:111]
    ds_read_b128 v[52:55], v9 offset:16384
    s_waitcnt lgkmcnt(7)
    v_mfma_f32_16x16x32_bf16 v[208:211], v[200:203], v[204:207], v[208:211]
    s_add_u32 m0, s62, 32768
    s_add_u32 s97, s59, s56
    buffer_load_dwordx4 v14, s[8:11], s97 offen lds
    buffer_load_dwordx4 v15, s[8:11], s97 offen offset:1024 lds
    v_mfma_f32_32x32x16_bf16 v[112:127], v[244:247], a[12:15], v[112:127]
    ds_read_b64_tr_b16 v[252:253], v12 offset:7168
    ds_read_b64_tr_b16 v[254:255], v12 offset:7424
    s_add_u32 m0, s6, 8192
    s_add_u32 s80, s60, s56
    buffer_load_dwordx4 v16, s[12:15], s80 offen offset:0 lds
    buffer_load_dwordx4 v17, s[12:15], s80 offen offset:1024 lds
    s_waitcnt lgkmcnt(7)
    v_mfma_f32_32x32x16_bf16 v[64:79], a[64:67], v[48:51], v[64:79]
    ds_read_b128 v[200:203], v213 offset:16384
    ds_read_b128 a[80:83], v6 offset:16384
    s_lshr_b32 s99, s5, 1
    s_add_u32 s98, s98, s99
    s_lshl_b32 s83, s98, 11
    s_add_u32 s83, s83, 1048576
    v_lshrrev_b32 v193, 5, v1
    v_mfma_f32_32x32x16_bf16 v[80:95], a[68:71], v[48:51], v[80:95]
    ds_read_b128 v[204:207], v214 offset:320
    ds_read_b128 a[84:87], v6 offset:20480
    v_lshlrev_b32 v172, 7, v193
    s_lshl_b32 s98, s99, 6
    s_add_u32 s98, s98, 156672
    v_add_u32 v172, s98, v172
    v_bfe_u32 v173, v1, 4, 1
    s_waitcnt lgkmcnt(9)
    v_mfma_f32_32x32x16_bf16 v[96:111], v[248:251], a[16:19], v[96:111]
    ds_read_b128 v[56:59], v10 offset:16384
    v_xor_b32 v173, v173, v193
    v_lshlrev_b32 v173, 1, v173
    v_bfe_u32 v174, v1, 1, 1
    v_bfe_u32 v192, v1, 3, 1
    v_xor_b32 v174, v174, v192
    v_mfma_f32_32x32x16_bf16 v[112:127], v[248:251], a[20:23], v[112:127]
    s_waitcnt vmcnt(16)
    ds_read_b64_tr_b16 v[240:241], v12 offset:12288
    ds_read_b64_tr_b16 v[242:243], v12 offset:12544
    v_or_b32 v173, v173, v174
    v_lshlrev_b32 v173, 4, v173
    v_and_b32 v174, 1, v1
    v_lshl_add_u32 v173, v174, 3, v173
    s_waitcnt lgkmcnt(9)
    v_mfma_f32_32x32x16_bf16 v[64:79], a[72:75], v[52:55], v[64:79]
    ds_read_b128 a[88:91], v7 offset:16384
    v_lshl_add_u32 v173, v193, 9, v173
    v_bfe_u32 v174, v1, 2, 2
    v_lshl_add_u32 v173, v174, 7, v173
    s_lshl_b32 s98, s99, 12
    s_and_b32 s99, s5, 1
    s_lshl_b32 s99, s99, 6
    v_mfma_f32_32x32x16_bf16 v[80:95], a[76:79], v[52:55], v[80:95]
    ds_read_b128 a[92:95], v7 offset:20480
    s_add_u32 s98, s98, s99
    v_add_u32 v173, s98, v173
    v_xor_b32 v174, 64, v173
    v_mul_u32_u24 v193, 57344, v193
    v_and_b32 v192, 31, v1
    s_waitcnt lgkmcnt(9)
    v_mfma_f32_32x32x16_bf16 v[96:111], v[252:255], a[24:27], v[96:111]
    ds_read_b128 v[60:63], v11 offset:16384
    s_waitcnt lgkmcnt(7)
    v_mfma_f32_16x16x32_bf16 v[208:211], v[200:203], v[204:207], v[208:211]
    s_add_u32 m0, s6, 10240
    s_nop 0
    buffer_load_dwordx4 v16, s[16:19], s80 offen offset:0 lds
    buffer_load_dwordx4 v17, s[16:19], s80 offen offset:1024 lds
    v_mfma_f32_32x32x16_bf16 v[112:127], v[252:255], a[28:31], v[112:127]
    ds_read_b64_tr_b16 v[244:245], v12 offset:13312
    ds_read_b64_tr_b16 v[246:247], v12 offset:13568
    v_lshl_add_u32 v223, v192, 2, v193
    v_min_u32 v192, 1, v1
    v_lshlrev_b32 v166, 30, v192
    s_add_u32 s98, s3, 1
    s_waitcnt lgkmcnt(7)
    v_mfma_f32_32x32x16_bf16 v[64:79], a[80:83], v[56:59], v[64:79]
    s_waitcnt vmcnt(10)
    s_barrier
    ds_read_b128 v[200:203], v212 offset:24576
    ds_read_b128 a[96:99], v4 offset:24576
    v_add_u32 v192, s98, v1
    v_subrev_u32 v193, 7, v192
    v_min_u32 v192, v192, v193
    v_mfma_f32_32x32x16_bf16 v[80:95], a[84:87], v[56:59], v[80:95]
    ds_read_b128 v[204:207], v214 offset:384
    ds_read_b128 a[100:103], v4 offset:28672
    v_lshlrev_b32 v192, 8, v192
    v_add_u32 v193, 58, v1
    v_lshrrev_b32 v193, 6, v193
    v_lshl_add_u32 v167, v193, 30, v192
    s_waitcnt lgkmcnt(9)
    v_mfma_f32_32x32x16_bf16 v[96:111], v[240:243], a[32:35], v[96:111]
    ds_read_b128 v[48:51], v8 offset:0
    s_mul_i32 s96, s55, 1792
    s_add_u32 m0, s6, 4096
    s_add_u32 s96, s96, s61
    buffer_load_dwordx4 v18, s[28:31], s96 offen offset:0 lds
    v_lshlrev_b32 v218, 16, v218
    v_mul_f32 v128, 0x3fb8aa3b, v218
    v_mfma_f32_32x32x16_bf16 v[112:127], v[240:243], a[36:39], v[112:127]
    ds_read_b64_tr_b16 v[248:249], v12 offset:14336
    ds_read_b64_tr_b16 v[250:251], v12 offset:14592
    buffer_load_dwordx4 v19, s[28:31], s96 offen offset:1024 lds
    v_exp_f32 v128, v128
    v_readfirstlane_b32 s7, v221
    s_waitcnt lgkmcnt(9)
    v_mfma_f32_32x32x16_bf16 v[64:79], a[88:91], v[60:63], v[64:79]
    ds_read_b128 a[104:107], v5 offset:24576
    buffer_load_dwordx4 v20, s[28:31], s96 offen offset:2048 lds
    v_lshlrev_b32 v216, 16, v216
    v_lshlrev_b32 v217, 16, v217
    v_cvt_pk_bf16_f32 v128, v128, v128
    v_lshlrev_b32 v128, 16, v128
    v_mfma_f32_32x32x16_bf16 v[80:95], a[92:95], v[60:63], v[80:95]
    ds_read_b128 a[108:111], v5 offset:28672
    buffer_load_dwordx4 v21, s[28:31], s96 offen offset:3072 lds
    v_mul_f32 v129, v128, v216
    v_mul_f32 v130, v128, v217
    v_mul_f32 v129, 0x3fb8aa3b, v129
    v_mul_f32 v130, 0.15915494, v130
    s_waitcnt lgkmcnt(9)
    v_mfma_f32_32x32x16_bf16 v[96:111], v[244:247], a[40:43], v[96:111]
    ds_read_b128 v[52:55], v9 offset:0
    s_waitcnt lgkmcnt(7)
    v_mfma_f32_16x16x32_bf16 v[208:211], v[200:203], v[204:207], v[208:211]
    s_add_u32 m0, s62, 40960
    s_add_u32 s97, s59, s57
    buffer_load_dwordx4 v14, s[8:11], s97 offen lds
    buffer_load_dwordx4 v15, s[8:11], s97 offen offset:1024 lds
    v_mfma_f32_32x32x16_bf16 v[112:127], v[244:247], a[44:47], v[112:127]
    ds_read_b64_tr_b16 v[252:253], v12 offset:15360
    ds_read_b64_tr_b16 v[254:255], v12 offset:15616
    s_add_u32 m0, s6, 16384
    s_add_u32 s80, s60, s57
    buffer_load_dwordx4 v16, s[12:15], s80 offen offset:0 lds
    buffer_load_dwordx4 v17, s[12:15], s80 offen offset:1024 lds
    s_waitcnt lgkmcnt(7)
    v_mfma_f32_32x32x16_bf16 v[64:79], a[96:99], v[48:51], v[64:79]
    ds_read_b128 v[200:203], v213 offset:24576
    ds_read_b128 a[112:115], v6 offset:24576
    v_exp_f32 v129, v129
    v_fract_f32 v130, v130
    v_mfma_f32_32x32x16_bf16 v[80:95], a[100:103], v[48:51], v[80:95]
    ds_read_b128 v[204:207], v214 offset:448
    ds_read_b128 a[116:119], v6 offset:28672
    v_cos_f32 v131, v130
    v_sin_f32 v132, v130
    s_add_u32 s7, s7, 2654435769
    s_waitcnt lgkmcnt(9)
    v_mfma_f32_32x32x16_bf16 v[96:111], v[248:251], a[48:51], v[96:111]
    ds_read_b128 v[56:59], v10 offset:0
    s_max_u32 s7, s7, 1
    v_mul_f32 v128, v216, v216
    v_fmac_f32 v128, v217, v217
    v_mul_f32 v30, v129, v131
    v_mul_f32 v31, v129, v132
    v_mfma_f32_32x32x16_bf16 v[112:127], v[248:251], a[52:55], v[112:127]
    s_waitcnt vmcnt(16)
    ds_read_b64_tr_b16 v[240:241], v12 offset:20480
    ds_read_b64_tr_b16 v[242:243], v12 offset:20736
    v_rcp_f32 v128, v128
    v_add_f32 v129, -1.0, v30
    v_mul_f32 v32, v129, v216
    s_waitcnt lgkmcnt(9)
    v_mfma_f32_32x32x16_bf16 v[64:79], a[104:107], v[52:55], v[64:79]
    ds_read_b128 a[120:123], v7 offset:24576
    v_mul_f32 v33, v31, v216
    v_fmac_f32 v32, v31, v217
    v_fma_f32 v33, -v129, v217, v33
    v_mul_f32 v32, v32, v128
    v_mul_f32 v33, v33, v128
    v_mfma_f32_32x32x16_bf16 v[80:95], a[108:111], v[52:55], v[80:95]
    ds_read_b128 a[124:127], v7 offset:28672
    v_mul_f32 v128, v31, v31
    v_add_f32 v129, v30, v30
    v_fma_f32 v128, v30, v30, -v128
    v_mul_f32 v129, v129, v31
    v_mul_f32 v130, v129, v129
    s_waitcnt lgkmcnt(9)
    v_mfma_f32_32x32x16_bf16 v[96:111], v[252:255], a[56:59], v[96:111]
    ds_read_b128 v[60:63], v11 offset:0
    s_waitcnt lgkmcnt(7)
    v_mfma_f32_16x16x32_bf16 v[208:211], v[200:203], v[204:207], v[208:211]
    s_add_u32 m0, s6, 18432
    s_nop 0
    buffer_load_dwordx4 v16, s[16:19], s80 offen offset:0 lds
    buffer_load_dwordx4 v17, s[16:19], s80 offen offset:1024 lds
    v_mfma_f32_32x32x16_bf16 v[112:127], v[252:255], a[60:63], v[112:127]
    ds_read_b64_tr_b16 v[244:245], v12 offset:21504
    ds_read_b64_tr_b16 v[246:247], v12 offset:21760
    v_add_f32 v131, v128, v128
    v_fma_f32 v130, v128, v128, -v130
    v_mul_f32 v131, v131, v129
    s_waitcnt lgkmcnt(7)
    v_mfma_f32_32x32x16_bf16 v[64:79], a[112:115], v[56:59], v[64:79]
    s_waitcnt vmcnt(10)
    s_barrier
    ds_read_b128 v[200:203], v212 offset:32768
    ds_read_b128 a[128:131], v4 offset:32768
    v_mul_f32 v128, v131, v131
    v_add_f32 v129, v130, v130
    v_fma_f32 v128, v130, v130, -v128
    v_mfma_f32_32x32x16_bf16 v[80:95], a[116:119], v[56:59], v[80:95]
    ds_read_b128 v[204:207], v214 offset:512
    ds_read_b128 a[132:135], v4 offset:36864
    v_mul_f32 v129, v129, v131
    v_mul_f32 v34, v129, v129
    v_add_f32 v35, v128, v128
    v_fma_f32 v34, v128, v128, -v34
    s_waitcnt lgkmcnt(9)
    v_mfma_f32_32x32x16_bf16 v[96:111], v[240:243], a[64:67], v[96:111]
    ds_read_b128 v[48:51], v8 offset:8192
    s_mul_i32 s96, s56, 1792
    s_add_u32 m0, s6, 12288
    s_add_u32 s96, s96, s61
    buffer_load_dwordx4 v18, s[28:31], s96 offen offset:0 lds
    v_mul_f32 v35, v35, v129
    v_mul_f32 v216, v35, v35
    v_add_f32 v217, v34, v34
    v_mfma_f32_32x32x16_bf16 v[112:127], v[240:243], a[68:71], v[112:127]
    ds_read_b64_tr_b16 v[248:249], v12 offset:22528
    ds_read_b64_tr_b16 v[250:251], v12 offset:22784
    buffer_load_dwordx4 v19, s[28:31], s96 offen offset:1024 lds
    v_fma_f32 v216, v34, v34, -v216
    v_mul_f32 v217, v217, v35
    s_waitcnt lgkmcnt(9)
    v_mfma_f32_32x32x16_bf16 v[64:79], a[120:123], v[60:63], v[64:79]
    ds_read_b128 a[136:139], v5 offset:32768
    buffer_load_dwordx4 v20, s[28:31], s96 offen offset:2048 lds
    v_mul_f32 v36, v217, v217
    v_add_f32 v37, v216, v216
    v_fma_f32 v36, v216, v216, -v36
    v_mul_f32 v37, v37, v217
    v_mfma_f32_32x32x16_bf16 v[80:95], a[124:127], v[60:63], v[80:95]
    ds_read_b128 a[140:143], v5 offset:36864
    buffer_load_dwordx4 v21, s[28:31], s96 offen offset:3072 lds
    v_mul_f32 v134, v216, v34
    v_mul_f32 v135, v216, v35
    v_fma_f32 v134, -v217, v35, v134
    v_fmac_f32 v135, v217, v34
    v_mul_f32 v128, v37, v37
    s_waitcnt lgkmcnt(9)
    v_mfma_f32_32x32x16_bf16 v[96:111], v[244:247], a[72:75], v[96:111]
    ds_read_b128 v[52:55], v9 offset:8192
    s_waitcnt lgkmcnt(7)
    v_mfma_f32_16x16x32_bf16 v[208:211], v[200:203], v[204:207], v[208:211]
    s_add_u32 m0, s62, 49152
    s_add_u32 s97, s59, s58
    buffer_load_dwordx4 v14, s[8:11], s97 offen lds
    buffer_load_dwordx4 v15, s[8:11], s97 offen offset:1024 lds
    v_mfma_f32_32x32x16_bf16 v[112:127], v[244:247], a[76:79], v[112:127]
    ds_read_b64_tr_b16 v[252:253], v12 offset:23552
    ds_read_b64_tr_b16 v[254:255], v12 offset:23808
    s_add_u32 m0, s6, 0
    s_add_u32 s80, s60, s58
    buffer_load_dwordx4 v16, s[12:15], s80 offen offset:0 lds
    buffer_load_dwordx4 v17, s[12:15], s80 offen offset:1024 lds
    s_waitcnt lgkmcnt(7)
    v_mfma_f32_32x32x16_bf16 v[64:79], a[128:131], v[48:51], v[64:79]
    ds_read_b128 v[200:203], v213 offset:32768
    ds_read_b128 a[144:147], v6 offset:32768
    v_add_f32 v129, v36, v36
    v_fma_f32 v128, v36, v36, -v128
    v_mul_f32 v129, v129, v37
    v_mfma_f32_32x32x16_bf16 v[80:95], a[132:135], v[48:51], v[80:95]
    ds_read_b128 v[204:207], v214 offset:576
    ds_read_b128 a[148:151], v6 offset:36864
    v_mul_f32 v130, v129, v129
    v_add_f32 v131, v128, v128
    v_fma_f32 v130, v128, v128, -v130
    v_mul_f32 v131, v131, v129
    s_waitcnt lgkmcnt(9)
    v_mfma_f32_32x32x16_bf16 v[96:111], v[248:251], a[80:83], v[96:111]
    ds_read_b128 v[56:59], v10 offset:8192
    v_mul_f32 v136, v131, v131
    v_add_f32 v137, v130, v130
    v_fma_f32 v136, v130, v130, -v136
    v_mul_f32 v137, v137, v131
    v_mul_f32 v138, v137, v137
    v_mfma_f32_32x32x16_bf16 v[112:127], v[248:251], a[84:87], v[112:127]
    s_waitcnt vmcnt(16)
    ds_read_b64_tr_b16 v[240:241], v12 offset:4096
    ds_read_b64_tr_b16 v[242:243], v12 offset:4352
    v_add_f32 v139, v136, v136
    v_fma_f32 v138, v136, v136, -v138
    v_mul_f32 v139, v139, v137
    v_mul_f32 v140, v138, v136
    s_waitcnt lgkmcnt(9)
    v_mfma_f32_32x32x16_bf16 v[64:79], a[136:139], v[52:55], v[64:79]
    ds_read_b128 a[152:155], v7 offset:32768
    v_mul_f32 v141, v138, v137
    v_fma_f32 v140, -v139, v137, v140
    v_fmac_f32 v141, v139, v136
    ds_read_b64 v[192:193], v47 offset:0
    ds_read_b64 v[194:195], v47 offset:16
    v_mfma_f32_32x32x16_bf16 v[80:95], a[140:143], v[52:55], v[80:95]
    ds_read_b128 a[156:159], v7 offset:36864
    ds_read_b64 v[196:197], v47 offset:32
    ds_read_b64 v[198:199], v47 offset:48
    s_mov_b32 s84, 0xffff0000
    s_mov_b32 s85, 0
    s_mov_b32 s86, 0
    s_mov_b32 s87, 0x0000ffff
    s_mov_b32 s88, 0
    s_waitcnt lgkmcnt(13)
    v_mfma_f32_32x32x16_bf16 v[96:111], v[252:255], a[88:91], v[96:111]
    ds_read_b128 v[60:63], v11 offset:8192
    s_waitcnt lgkmcnt(11)
    v_mfma_f32_16x16x32_bf16 v[208:211], v[200:203], v[204:207], v[208:211]
    s_add_u32 m0, s6, 2048
    s_nop 0
    buffer_load_dwordx4 v16, s[16:19], s80 offen offset:0 lds
    buffer_load_dwordx4 v17, s[16:19], s80 offen offset:1024 lds
    v_mfma_f32_32x32x16_bf16 v[112:127], v[252:255], a[92:95], v[112:127]
    ds_read_b64_tr_b16 v[244:245], v12 offset:5120
    ds_read_b64_tr_b16 v[246:247], v12 offset:5376
    s_mov_b32 s89, 0xffff0000
    v_cndmask_b32 v38, 1.0, v34, s[84:85]
    v_cndmask_b32 v39, 0, v35, s[84:85]
    s_waitcnt lgkmcnt(11)
    v_mfma_f32_32x32x16_bf16 v[64:79], a[144:147], v[56:59], v[64:79]
    s_waitcnt vmcnt(10)
    s_barrier
    ds_read_b128 v[200:203], v212 offset:40960
    ds_read_b128 a[160:163], v4 offset:40960
    v_cndmask_b32 v38, v38, v216, s[86:87]
    v_cndmask_b32 v39, v39, v217, s[86:87]
    v_cndmask_b32 v38, v38, v134, s[88:89]
    v_mfma_f32_32x32x16_bf16 v[80:95], a[148:151], v[56:59], v[80:95]
    ds_read_b128 v[204:207], v214 offset:640
    ds_read_b128 a[164:167], v4 offset:45056
    v_cndmask_b32 v39, v39, v135, s[88:89]
    v_cndmask_b32 v40, 1.0, v136, s[84:85]
    v_cndmask_b32 v41, 0, v137, s[84:85]
    v_cndmask_b32 v40, v40, v138, s[86:87]
    v_cndmask_b32 v41, v41, v139, s[86:87]
    s_waitcnt lgkmcnt(13)
    v_mfma_f32_32x32x16_bf16 v[96:111], v[240:243], a[96:99], v[96:111]
    ds_read_b128 v[48:51], v8 offset:16384
    s_mul_i32 s96, s57, 1792
    s_add_u32 m0, s6, 20480
    s_add_u32 s96, s96, s61
    buffer_load_dwordx4 v18, s[28:31], s96 offen offset:0 lds
    v_cndmask_b32 v40, v40, v140, s[88:89]
    v_cndmask_b32 v41, v41, v141, s[88:89]
    v_mfma_f32_32x32x16_bf16 v[112:127], v[240:243], a[100:103], v[112:127]
    ds_read_b64_tr_b16 v[248:249], v12 offset:6144
    ds_read_b64_tr_b16 v[250:251], v12 offset:6400
    buffer_load_dwordx4 v19, s[28:31], s96 offen offset:1024 lds
    v_lshlrev_b32 v220, 16, v220
    v_lshlrev_b32 v219, 16, v219
    s_waitcnt lgkmcnt(9)
    v_mfma_f32_32x32x16_bf16 v[64:79], a[152:155], v[60:63], v[64:79]
    ds_read_b128 a[168:171], v5 offset:40960
    buffer_load_dwordx4 v20, s[28:31], s96 offen offset:2048 lds
    v_lshlrev_b32 v176, 16, v192
    v_and_b32 v177, 0xffff0000, v192
    v_lshlrev_b32 v178, 16, v193
    v_and_b32 v179, 0xffff0000, v193
    v_lshlrev_b32 v180, 16, v194
    v_mfma_f32_32x32x16_bf16 v[80:95], a[156:159], v[60:63], v[80:95]
    ds_read_b128 a[172:175], v5 offset:45056
    buffer_load_dwordx4 v21, s[28:31], s96 offen offset:3072 lds
    v_and_b32 v181, 0xffff0000, v194
    v_lshlrev_b32 v182, 16, v195
    v_and_b32 v183, 0xffff0000, v195
    v_lshlrev_b32 v184, 16, v196
    s_waitcnt lgkmcnt(9)
    v_mfma_f32_32x32x16_bf16 v[96:111], v[244:247], a[104:107], v[96:111]
    ds_read_b128 v[52:55], v9 offset:16384
    s_waitcnt lgkmcnt(7)
    v_mfma_f32_16x16x32_bf16 v[208:211], v[200:203], v[204:207], v[208:211]
    s_mul_i32 s96, s58, 1792
    s_add_u32 m0, s6, 4096
    s_add_u32 s96, s96, s61
    buffer_load_dwordx4 v18, s[28:31], s96 offen offset:0 lds
    v_mfma_f32_32x32x16_bf16 v[112:127], v[244:247], a[108:111], v[112:127]
    ds_read_b64_tr_b16 v[252:253], v12 offset:7168
    ds_read_b64_tr_b16 v[254:255], v12 offset:7424
    buffer_load_dwordx4 v19, s[28:31], s96 offen offset:1024 lds
    v_and_b32 v185, 0xffff0000, v196
    v_lshlrev_b32 v186, 16, v197
    s_waitcnt lgkmcnt(7)
    v_mfma_f32_32x32x16_bf16 v[64:79], a[160:163], v[48:51], v[64:79]
    ds_read_b128 v[200:203], v213 offset:40960
    ds_read_b128 a[176:179], v6 offset:40960
    v_and_b32 v187, 0xffff0000, v197
    v_lshlrev_b32 v188, 16, v198
    v_and_b32 v189, 0xffff0000, v198
    v_lshlrev_b32 v190, 16, v199
    v_mfma_f32_32x32x16_bf16 v[80:95], a[164:167], v[48:51], v[80:95]
    ds_read_b128 v[204:207], v214 offset:704
    ds_read_b128 a[180:183], v6 offset:45056
    v_and_b32 v191, 0xffff0000, v199
    s_waitcnt lgkmcnt(9)
    v_mfma_f32_32x32x16_bf16 v[96:111], v[248:251], a[112:115], v[96:111]
    ds_read_b128 v[56:59], v10 offset:16384
    buffer_load_dwordx4 v20, s[28:31], s96 offen offset:2048 lds
    v_mfma_f32_32x32x16_bf16 v[112:127], v[248:251], a[116:119], v[112:127]
    s_waitcnt vmcnt(15)
    ds_read_b64_tr_b16 v[240:241], v12 offset:12288
    ds_read_b64_tr_b16 v[242:243], v12 offset:12544
    s_waitcnt lgkmcnt(9)
    v_mfma_f32_32x32x16_bf16 v[64:79], a[168:171], v[52:55], v[64:79]
    ds_read_b128 a[184:187], v7 offset:40960
    v_mfma_f32_32x32x16_bf16 v[80:95], a[172:175], v[52:55], v[80:95]
    ds_read_b128 a[188:191], v7 offset:45056
    s_waitcnt lgkmcnt(9)
    v_mfma_f32_32x32x16_bf16 v[96:111], v[252:255], a[120:123], v[96:111]
    ds_read_b128 v[60:63], v11 offset:16384
    s_waitcnt lgkmcnt(7)
    v_mfma_f32_16x16x32_bf16 v[208:211], v[200:203], v[204:207], v[208:211]
    buffer_load_dwordx4 v21, s[28:31], s96 offen offset:3072 lds
    s_xor_b32 s61, s61, 128
    v_mfma_f32_32x32x16_bf16 v[112:127], v[252:255], a[124:127], v[112:127]
    ds_read_b64_tr_b16 v[244:245], v12 offset:13312
    ds_read_b64_tr_b16 v[246:247], v12 offset:13568
    s_mul_i32 s96, s52, 1792
    s_add_u32 m0, s6, 8192
    s_add_u32 s96, s96, s61
    buffer_load_dwordx4 v18, s[28:31], s96 offen offset:0 lds
    s_waitcnt lgkmcnt(7)
    v_mfma_f32_32x32x16_bf16 v[64:79], a[176:179], v[56:59], v[64:79]
    s_waitcnt vmcnt(9)
    s_barrier
    ds_read_b128 v[200:203], v212 offset:49152
    ds_read_b128 a[192:195], v4 offset:49152
    buffer_load_dwordx4 v19, s[28:31], s96 offen offset:1024 lds
    v_mfma_f32_32x32x16_bf16 v[80:95], a[180:183], v[56:59], v[80:95]
    ds_read_b128 v[204:207], v214 offset:768
    ds_read_b128 a[196:199], v4 offset:53248
    s_waitcnt lgkmcnt(9)
    v_mfma_f32_32x32x16_bf16 v[96:111], v[240:243], a[128:131], v[96:111]
    ds_read_b128 v[48:51], v8 offset:0
    buffer_load_dwordx4 v20, s[28:31], s96 offen offset:2048 lds
    v_mfma_f32_32x32x16_bf16 v[112:127], v[240:243], a[132:135], v[112:127]
    ds_read_b64_tr_b16 v[248:249], v12 offset:14336
    ds_read_b64_tr_b16 v[250:251], v12 offset:14592
    buffer_load_dwordx4 v21, s[28:31], s96 offen offset:3072 lds
    s_waitcnt lgkmcnt(9)
    v_mfma_f32_32x32x16_bf16 v[64:79], a[184:187], v[60:63], v[64:79]
    ds_read_b128 a[200:203], v5 offset:49152
    s_mul_i32 s96, s53, 1792
    s_add_u32 m0, s6, 12288
    s_add_u32 s96, s96, s61
    buffer_load_dwordx4 v18, s[28:31], s96 offen offset:0 lds
    v_mfma_f32_32x32x16_bf16 v[80:95], a[188:191], v[60:63], v[80:95]
    ds_read_b128 a[204:207], v5 offset:53248
    s_waitcnt lgkmcnt(9)
    v_mfma_f32_32x32x16_bf16 v[96:111], v[244:247], a[136:139], v[96:111]
    ds_read_b128 v[52:55], v9 offset:0
    s_waitcnt lgkmcnt(7)
    v_mfma_f32_16x16x32_bf16 v[208:211], v[200:203], v[204:207], v[208:211]
    buffer_load_dwordx4 v19, s[28:31], s96 offen offset:1024 lds
    v_mfma_f32_32x32x16_bf16 v[112:127], v[244:247], a[140:143], v[112:127]
    ds_read_b64_tr_b16 v[252:253], v12 offset:15360
    ds_read_b64_tr_b16 v[254:255], v12 offset:15616
    s_waitcnt lgkmcnt(7)
    v_mfma_f32_32x32x16_bf16 v[64:79], a[192:195], v[48:51], v[64:79]
    ds_read_b128 v[200:203], v213 offset:49152
    ds_read_b128 a[208:211], v6 offset:49152
    v_mfma_f32_32x32x16_bf16 v[80:95], a[196:199], v[48:51], v[80:95]
    ds_read_b128 v[204:207], v214 offset:832
    ds_read_b128 a[212:215], v6 offset:53248
    s_waitcnt lgkmcnt(9)
    v_mfma_f32_32x32x16_bf16 v[96:111], v[248:251], a[144:147], v[96:111]
    ds_read_b128 v[56:59], v10 offset:0
    buffer_load_dwordx4 v20, s[28:31], s96 offen offset:2048 lds
    v_mfma_f32_32x32x16_bf16 v[112:127], v[248:251], a[148:151], v[112:127]
    s_waitcnt vmcnt(13)
    ds_read_b64_tr_b16 v[240:241], v12 offset:20480
    ds_read_b64_tr_b16 v[242:243], v12 offset:20736
    s_waitcnt lgkmcnt(9)
    v_mfma_f32_32x32x16_bf16 v[64:79], a[200:203], v[52:55], v[64:79]
    ds_read_b128 a[216:219], v7 offset:49152
    v_mfma_f32_32x32x16_bf16 v[80:95], a[204:207], v[52:55], v[80:95]
    ds_read_b128 a[220:223], v7 offset:53248
    s_waitcnt lgkmcnt(9)
    v_mfma_f32_32x32x16_bf16 v[96:111], v[252:255], a[152:155], v[96:111]
    ds_read_b128 v[60:63], v11 offset:0
    s_waitcnt lgkmcnt(7)
    v_mfma_f32_16x16x32_bf16 v[208:211], v[200:203], v[204:207], v[208:211]
    buffer_load_dwordx4 v21, s[28:31], s96 offen offset:3072 lds
    v_mfma_f32_32x32x16_bf16 v[112:127], v[252:255], a[156:159], v[112:127]
    ds_read_b64_tr_b16 v[244:245], v12 offset:21504
    ds_read_b64_tr_b16 v[246:247], v12 offset:21760
    s_mul_i32 s96, s54, 1792
    s_add_u32 m0, s6, 16384
    s_add_u32 s96, s96, s61
    buffer_load_dwordx4 v18, s[28:31], s96 offen offset:0 lds
    s_waitcnt lgkmcnt(7)
    v_mfma_f32_32x32x16_bf16 v[64:79], a[208:211], v[56:59], v[64:79]
    buffer_load_dwordx4 v19, s[28:31], s96 offen offset:1024 lds
    s_mov_b32 vcc_lo, 0x00f000f0
    s_mov_b32 vcc_hi, 0x00f000f0
    v_cndmask_b32 v208, v208, v209, vcc
    s_mov_b32 vcc_lo, 0x0f000f00
    s_mov_b32 vcc_hi, 0x0f000f00
    v_cndmask_b32 v208, v208, v210, vcc
    v_mfma_f32_32x32x16_bf16 v[80:95], a[212:215], v[56:59], v[80:95]
    buffer_load_dwordx4 v20, s[28:31], s96 offen offset:2048 lds
    s_mov_b32 vcc_lo, 0xf000f000
    s_mov_b32 vcc_hi, 0xf000f000
    v_cndmask_b32 v208, v208, v211, vcc
    v_cvt_pk_bf16_f32 v208, v208, v208
    v_lshlrev_b32 v208, 16, v208
    v_mul_f32 v208, 0xbfb8aa3b, v208
    s_waitcnt lgkmcnt(5)
    v_mfma_f32_32x32x16_bf16 v[96:111], v[240:243], a[160:163], v[96:111]
    buffer_load_dwordx4 v21, s[28:31], s96 offen offset:3072 lds
    v_exp_f32 v208, v208
    s_mov_b32 vcc_lo, 0x22222222
    v_add_f32 v208, 1.0, v208
    v_rcp_f32 v208, v208
    v_mfma_f32_32x32x16_bf16 v[112:127], v[240:243], a[164:167], v[112:127]
    s_waitcnt vmcnt(16)
    ds_read_b64_tr_b16 v[248:249], v12 offset:22528
    ds_read_b64_tr_b16 v[250:251], v12 offset:22784
    s_mul_i32 s96, s55, 1792
    s_add_u32 m0, s6, 20480
    s_add_u32 s96, s96, s61
    buffer_load_dwordx4 v18, s[28:31], s96 offen offset:0 lds
    s_mov_b32 vcc_hi, 0x22222222
    s_waitcnt lgkmcnt(4)
    v_mfma_f32_32x32x16_bf16 v[64:79], a[216:219], v[60:63], v[64:79]
    v_cvt_pk_bf16_f32 v208, v208, v208
    v_lshlrev_b32 v208, 16, v208
    v_sub_f32 v193, 1.0, v208
    v_cvt_pk_bf16_f32 v193, v193, v193
    v_lshlrev_b32 v193, 16, v193
    v_max_f32 v194, 0x0da24260, v193
    v_mfma_f32_32x32x16_bf16 v[80:95], a[220:223], v[60:63], v[80:95]
    v_rcp_f32 v194, v194
    v_add_f32 v195, v208, v208
    v_cndmask_b32 v208, v208, v193, vcc
    s_mov_b32 vcc_lo, 0x44444444
    s_mov_b32 vcc_hi, 0x44444444
    v_cndmask_b32 v208, v208, v194, vcc
    s_mov_b32 vcc_lo, 0x88888888
    s_waitcnt lgkmcnt(2)
    v_mfma_f32_32x32x16_bf16 v[96:111], v[244:247], a[168:171], v[96:111]
    buffer_load_dwordx4 v19, s[28:31], s96 offen offset:1024 lds
    s_mov_b32 vcc_hi, 0x88888888
    v_cndmask_b32 v170, v208, v195, vcc
    v_mfma_f32_32x32x16_bf16 v[112:127], v[244:247], a[172:175], v[112:127]
    ds_read_b64_tr_b16 v[252:253], v12 offset:23552
    ds_read_b64_tr_b16 v[254:255], v12 offset:23808
    s_waitcnt lgkmcnt(2)
    v_mfma_f32_32x32x16_bf16 v[96:111], v[248:251], a[176:179], v[96:111]
    s_waitcnt vmcnt(16)
    ds_read_b64_tr_b16 v[240:241], v12 offset:4096
    ds_read_b64_tr_b16 v[242:243], v12 offset:4352
    v_mfma_f32_32x32x16_bf16 v[112:127], v[248:251], a[180:183], v[112:127]
    buffer_load_dwordx4 v20, s[28:31], s96 offen offset:2048 lds
    v_permlane16_swap_b32 v64, v80
    v_permlane16_swap_b32 v65, v81
    s_waitcnt lgkmcnt(2)
    v_mfma_f32_32x32x16_bf16 v[96:111], v[252:255], a[184:187], v[96:111]
    ds_read_b64_tr_b16 v[244:245], v12 offset:5120
    ds_read_b64_tr_b16 v[246:247], v12 offset:5376
    v_permlane16_swap_b32 v66, v82
    v_permlane16_swap_b32 v67, v83
    v_mfma_f32_32x32x16_bf16 v[112:127], v[252:255], a[188:191], v[112:127]
    buffer_load_dwordx4 v21, s[28:31], s96 offen offset:3072 lds
    v_permlane16_swap_b32 v68, v84
    v_permlane16_swap_b32 v69, v85
    v_permlane16_swap_b32 v70, v86
    s_waitcnt lgkmcnt(2)
    v_mfma_f32_32x32x16_bf16 v[96:111], v[240:243], a[192:195], v[96:111]
    s_waitcnt vmcnt(16)
    ds_read_b64_tr_b16 v[248:249], v12 offset:6144
    ds_read_b64_tr_b16 v[250:251], v12 offset:6400
    v_permlane16_swap_b32 v71, v87
    v_mfma_f32_32x32x16_bf16 v[112:127], v[240:243], a[196:199], v[112:127]
    s_mul_i32 s96, s56, 1792
    s_add_u32 m0, s6, 0
    s_add_u32 s96, s96, s61
    buffer_load_dwordx4 v18, s[28:31], s96 offen offset:0 lds
    v_permlane16_swap_b32 v72, v88
    v_permlane16_swap_b32 v73, v89
    s_waitcnt lgkmcnt(2)
    v_mfma_f32_32x32x16_bf16 v[96:111], v[244:247], a[200:203], v[96:111]
    ds_read_b64_tr_b16 v[252:253], v12 offset:7168
    ds_read_b64_tr_b16 v[254:255], v12 offset:7424
    v_permlane16_swap_b32 v74, v90
    v_permlane16_swap_b32 v75, v91
    v_mfma_f32_32x32x16_bf16 v[112:127], v[244:247], a[204:207], v[112:127]
    buffer_load_dwordx4 v19, s[28:31], s96 offen offset:1024 lds
    v_permlane16_swap_b32 v76, v92
    v_permlane16_swap_b32 v77, v93
    s_waitcnt lgkmcnt(2)
    v_mfma_f32_32x32x16_bf16 v[96:111], v[248:251], a[208:211], v[96:111]
    s_waitcnt vmcnt(16)
    ds_read_b64_tr_b16 v[48:49], v12 offset:8192
    ds_read_b64_tr_b16 v[50:51], v12 offset:8448
    v_permlane16_swap_b32 v78, v94
    v_permlane16_swap_b32 v79, v95
    v_mul_f32 v192, v64, v33
    v_mfma_f32_32x32x16_bf16 v[112:127], v[248:251], a[212:215], v[112:127]
    buffer_load_dwordx4 v20, s[28:31], s96 offen offset:2048 lds
    v_mul_f32 v64, v64, v32
    v_fma_f32 v64, -v80, v33, v64
    v_fma_f32 v80, v80, v32, v192
    v_mul_f32 v193, v65, v33
    v_mul_f32 v65, v65, v32
    s_waitcnt lgkmcnt(2)
    v_mfma_f32_32x32x16_bf16 v[96:111], v[252:255], a[216:219], v[96:111]
    ds_read_b64_tr_b16 v[52:53], v12 offset:9216
    ds_read_b64_tr_b16 v[54:55], v12 offset:9472
    v_fma_f32 v65, -v81, v33, v65
    v_fma_f32 v81, v81, v32, v193
    v_fma_f32 v194, v64, v30, v65
    v_fma_f32 v195, v64, v31, v81
    v_mfma_f32_32x32x16_bf16 v[112:127], v[252:255], a[220:223], v[112:127]
    buffer_load_dwordx4 v21, s[28:31], s96 offen offset:3072 lds
    v_fma_f32 v194, -v80, v31, v194
    v_fmac_f32 v195, v80, v30
    v_mul_f32 v192, v66, v33
    v_mul_f32 v66, v66, v32
    v_fma_f32 v66, -v82, v33, v66
    s_waitcnt lgkmcnt(2)
    v_mfma_f32_32x32x16_bf16 v[128:143], v[48:51], a[0:3], v[176:191]
    s_waitcnt vmcnt(16)
    ds_read_b64_tr_b16 v[56:57], v12 offset:10240
    ds_read_b64_tr_b16 v[58:59], v12 offset:10496
    v_fma_f32 v82, v82, v32, v192
    v_fma_f32 v196, v194, v30, v66
    v_fma_f32 v197, v194, v31, v82
    v_mfma_f32_32x32x16_bf16 v[144:159], v[48:51], a[4:7], v[176:191]
    v_fma_f32 v196, -v195, v31, v196
    v_fmac_f32 v197, v195, v30
    v_mul_f32 v193, v67, v33
    v_mul_f32 v67, v67, v32
    v_fma_f32 v67, -v83, v33, v67
    v_fma_f32 v83, v83, v32, v193
    s_waitcnt lgkmcnt(2)
    v_mfma_f32_32x32x16_bf16 v[128:143], v[52:55], a[8:11], v[128:143]
    ds_read_b64_tr_b16 v[60:61], v12 offset:11264
    ds_read_b64_tr_b16 v[62:63], v12 offset:11520
    v_fma_f32 v194, v196, v30, v67
    v_fma_f32 v195, v196, v31, v83
    v_fma_f32 v194, -v197, v31, v194
    v_mfma_f32_32x32x16_bf16 v[144:159], v[52:55], a[12:15], v[144:159]
    v_fmac_f32 v195, v197, v30
    v_mul_f32 v192, v68, v33
    v_mul_f32 v68, v68, v32
    v_fma_f32 v68, -v84, v33, v68
    v_fma_f32 v84, v84, v32, v192
    s_waitcnt lgkmcnt(2)
    v_mfma_f32_32x32x16_bf16 v[128:143], v[56:59], a[16:19], v[128:143]
    s_waitcnt vmcnt(14)
    ds_read_b64_tr_b16 v[48:49], v12 offset:12288
    ds_read_b64_tr_b16 v[50:51], v12 offset:12544
    v_fma_f32 v196, v194, v30, v68
    v_fma_f32 v197, v194, v31, v84
    v_fma_f32 v196, -v195, v31, v196
    v_mfma_f32_32x32x16_bf16 v[144:159], v[56:59], a[20:23], v[144:159]
    s_mul_i32 s96, s57, 1792
    s_add_u32 m0, s6, 4096
    s_add_u32 s96, s96, s61
    buffer_load_dwordx4 v18, s[28:31], s96 offen offset:0 lds
    v_fmac_f32 v197, v195, v30
    v_mul_f32 v193, v69, v33
    v_mul_f32 v69, v69, v32
    s_waitcnt lgkmcnt(2)
    v_mfma_f32_32x32x16_bf16 v[128:143], v[60:63], a[24:27], v[128:143]
    ds_read_b64_tr_b16 v[52:53], v12 offset:13312
    ds_read_b64_tr_b16 v[54:55], v12 offset:13568
    v_fma_f32 v69, -v85, v33, v69
    v_fma_f32 v85, v85, v32, v193
    v_fma_f32 v194, v196, v30, v69
    v_mfma_f32_32x32x16_bf16 v[144:159], v[60:63], a[28:31], v[144:159]
    buffer_load_dwordx4 v19, s[28:31], s96 offen offset:1024 lds
    v_fma_f32 v195, v196, v31, v85
    v_fma_f32 v194, -v197, v31, v194
    v_fmac_f32 v195, v197, v30
    v_mul_f32 v192, v70, v33
    v_mul_f32 v70, v70, v32
    s_waitcnt lgkmcnt(2)
    v_mfma_f32_32x32x16_bf16 v[128:143], v[48:51], a[32:35], v[128:143]
    s_waitcnt vmcnt(14)
    ds_read_b64_tr_b16 v[56:57], v12 offset:14336
    ds_read_b64_tr_b16 v[58:59], v12 offset:14592
    v_fma_f32 v70, -v86, v33, v70
    v_fma_f32 v86, v86, v32, v192
    v_fma_f32 v196, v194, v30, v70
    v_mfma_f32_32x32x16_bf16 v[144:159], v[48:51], a[36:39], v[144:159]
    buffer_load_dwordx4 v20, s[28:31], s96 offen offset:2048 lds
    v_fma_f32 v197, v194, v31, v86
    v_fma_f32 v196, -v195, v31, v196
    v_fmac_f32 v197, v195, v30
    v_mul_f32 v193, v71, v33
    v_mul_f32 v71, v71, v32
    s_waitcnt lgkmcnt(2)
    v_mfma_f32_32x32x16_bf16 v[128:143], v[52:55], a[40:43], v[128:143]
    ds_read_b64_tr_b16 v[60:61], v12 offset:15360
    ds_read_b64_tr_b16 v[62:63], v12 offset:15616
    v_fma_f32 v71, -v87, v33, v71
    v_fma_f32 v87, v87, v32, v193
    v_fma_f32 v194, v196, v30, v71
    v_mfma_f32_32x32x16_bf16 v[144:159], v[52:55], a[44:47], v[144:159]
    buffer_load_dwordx4 v21, s[28:31], s96 offen offset:3072 lds
    v_fma_f32 v195, v196, v31, v87
    v_fma_f32 v194, -v197, v31, v194
    v_fmac_f32 v195, v197, v30
    v_mul_f32 v192, v72, v33
    s_waitcnt lgkmcnt(2)
    v_mfma_f32_32x32x16_bf16 v[128:143], v[56:59], a[48:51], v[128:143]
    s_waitcnt vmcnt(14)
    ds_read_b64_tr_b16 v[48:49], v12 offset:16384
    ds_read_b64_tr_b16 v[50:51], v12 offset:16640
    v_mul_f32 v72, v72, v32
    v_fma_f32 v72, -v88, v33, v72
    v_fma_f32 v88, v88, v32, v192
    v_mfma_f32_32x32x16_bf16 v[144:159], v[56:59], a[52:55], v[144:159]
    s_mul_i32 s96, s58, 1792
    s_add_u32 m0, s6, 8192
    s_add_u32 s96, s96, s61
    buffer_load_dwordx4 v18, s[28:31], s96 offen offset:0 lds
    v_fma_f32 v196, v194, v30, v72
    v_fma_f32 v197, v194, v31, v88
    v_fma_f32 v196, -v195, v31, v196
    s_waitcnt lgkmcnt(2)
    v_mfma_f32_32x32x16_bf16 v[128:143], v[60:63], a[56:59], v[128:143]
    ds_read_b64_tr_b16 v[52:53], v12 offset:17408
    ds_read_b64_tr_b16 v[54:55], v12 offset:17664
    v_fmac_f32 v197, v195, v30
    v_mul_f32 v193, v73, v33
    v_mul_f32 v73, v73, v32
    v_mfma_f32_32x32x16_bf16 v[144:159], v[60:63], a[60:63], v[144:159]
    buffer_load_dwordx4 v19, s[28:31], s96 offen offset:1024 lds
    v_fma_f32 v73, -v89, v33, v73
    v_fma_f32 v89, v89, v32, v193
    v_fma_f32 v194, v196, v30, v73
    v_fma_f32 v195, v196, v31, v89
    v_fma_f32 v194, -v197, v31, v194
    s_waitcnt lgkmcnt(2)
    v_mfma_f32_32x32x16_bf16 v[128:143], v[48:51], a[64:67], v[128:143]
    s_waitcnt vmcnt(14)
    ds_read_b64_tr_b16 v[56:57], v12 offset:18432
    ds_read_b64_tr_b16 v[58:59], v12 offset:18688
    v_fmac_f32 v195, v197, v30
    v_mul_f32 v192, v74, v33
    v_mul_f32 v74, v74, v32
    v_mfma_f32_32x32x16_bf16 v[144:159], v[48:51], a[68:71], v[144:159]
    buffer_load_dwordx4 v20, s[28:31], s96 offen offset:2048 lds
    v_fma_f32 v74, -v90, v33, v74
    v_fma_f32 v90, v90, v32, v192
    v_fma_f32 v196, v194, v30, v74
    v_fma_f32 v197, v194, v31, v90
    v_fma_f32 v196, -v195, v31, v196
    s_waitcnt lgkmcnt(2)
    v_mfma_f32_32x32x16_bf16 v[128:143], v[52:55], a[72:75], v[128:143]
    ds_read_b64_tr_b16 v[60:61], v12 offset:19456
    ds_read_b64_tr_b16 v[62:63], v12 offset:19712
    v_fmac_f32 v197, v195, v30
    v_mul_f32 v193, v75, v33
    v_mul_f32 v75, v75, v32
    v_mfma_f32_32x32x16_bf16 v[144:159], v[52:55], a[76:79], v[144:159]
    buffer_load_dwordx4 v21, s[28:31], s96 offen offset:3072 lds
    v_fma_f32 v75, -v91, v33, v75
    v_fma_f32 v91, v91, v32, v193
    v_fma_f32 v194, v196, v30, v75
    v_fma_f32 v195, v196, v31, v91
    s_waitcnt lgkmcnt(2)
    v_mfma_f32_32x32x16_bf16 v[128:143], v[56:59], a[80:83], v[128:143]
    s_waitcnt vmcnt(14)
    ds_read_b64_tr_b16 v[48:49], v12 offset:20480
    ds_read_b64_tr_b16 v[50:51], v12 offset:20736
    v_fma_f32 v194, -v197, v31, v194
    v_fmac_f32 v195, v197, v30
    v_mul_f32 v192, v76, v33
    v_mfma_f32_32x32x16_bf16 v[144:159], v[56:59], a[84:87], v[144:159]
    s_add_u32 m0, s6, 12288
    s_add_u32 s96, s64, 0
    buffer_load_dwordx4 v22, s[32:35], s96 offen offset:0 lds
    v_mul_f32 v76, v76, v32
    v_fma_f32 v76, -v92, v33, v76
    v_fma_f32 v92, v92, v32, v192
    v_fma_f32 v196, v194, v30, v76
    s_waitcnt lgkmcnt(2)
    v_mfma_f32_32x32x16_bf16 v[128:143], v[60:63], a[88:91], v[128:143]
    ds_read_b64_tr_b16 v[52:53], v12 offset:21504
    ds_read_b64_tr_b16 v[54:55], v12 offset:21760
    v_fma_f32 v197, v194, v31, v92
    v_fma_f32 v196, -v195, v31, v196
    v_fmac_f32 v197, v195, v30
    v_mfma_f32_32x32x16_bf16 v[144:159], v[60:63], a[92:95], v[144:159]
    buffer_load_dwordx4 v23, s[32:35], s96 offen offset:1024 lds
    v_mul_f32 v193, v77, v33
    v_mul_f32 v77, v77, v32
    v_fma_f32 v77, -v93, v33, v77
    v_fma_f32 v93, v93, v32, v193
    v_fma_f32 v194, v196, v30, v77
    s_waitcnt lgkmcnt(2)
    v_mfma_f32_32x32x16_bf16 v[128:143], v[48:51], a[96:99], v[128:143]
    s_waitcnt vmcnt(14)
    ds_read_b64_tr_b16 v[56:57], v12 offset:22528
    ds_read_b64_tr_b16 v[58:59], v12 offset:22784
    v_fma_f32 v195, v196, v31, v93
    v_fma_f32 v194, -v197, v31, v194
    v_fmac_f32 v195, v197, v30
    v_mfma_f32_32x32x16_bf16 v[144:159], v[48:51], a[100:103], v[144:159]
    buffer_load_dwordx4 v24, s[32:35], s96 offen offset:2048 lds
    v_mul_f32 v192, v78, v33
    v_mul_f32 v78, v78, v32
    v_fma_f32 v78, -v94, v33, v78
    v_fma_f32 v94, v94, v32, v192
    s_waitcnt lgkmcnt(2)
    v_mfma_f32_32x32x16_bf16 v[128:143], v[52:55], a[104:107], v[128:143]
    ds_read_b64_tr_b16 v[60:61], v12 offset:23552
    ds_read_b64_tr_b16 v[62:63], v12 offset:23808
    v_fma_f32 v196, v194, v30, v78
    v_fma_f32 v197, v194, v31, v94
    v_fma_f32 v196, -v195, v31, v196
    v_mfma_f32_32x32x16_bf16 v[144:159], v[52:55], a[108:111], v[144:159]
    buffer_load_dwordx4 v25, s[32:35], s96 offen offset:3072 lds
    v_fmac_f32 v197, v195, v30
    v_mul_f32 v193, v79, v33
    v_mul_f32 v79, v79, v32
    v_fma_f32 v79, -v95, v33, v79
    v_fma_f32 v95, v95, v32, v193
    s_waitcnt lgkmcnt(2)
    v_mfma_f32_32x32x16_bf16 v[128:143], v[56:59], a[112:115], v[128:143]
    s_waitcnt vmcnt(14)
    ds_read_b64_tr_b16 v[48:49], v12 offset:0
    ds_read_b64_tr_b16 v[50:51], v12 offset:256
    v_fma_f32 v44, v196, v30, v79
    v_fma_f32 v45, v196, v31, v95
    v_fma_f32 v44, -v197, v31, v44
    v_mfma_f32_32x32x16_bf16 v[144:159], v[56:59], a[116:119], v[144:159]
    s_add_u32 m0, s6, 16384
    s_add_u32 s96, s64, 57344
    buffer_load_dwordx4 v22, s[32:35], s96 offen offset:0 lds
    v_fmac_f32 v45, v197, v30
    v_mov_b32 v192, v44
    v_mov_b32 v193, v45
    s_waitcnt lgkmcnt(2)
    v_mfma_f32_32x32x16_bf16 v[128:143], v[60:63], a[120:123], v[128:143]
    ds_read_b64_tr_b16 v[52:53], v12 offset:1024
    ds_read_b64_tr_b16 v[54:55], v12 offset:1280
    v_mov_b32 v209, s7
    v_mov_b32 v211, s7
    v_permlane16_swap_b32 v44, v192
    v_mfma_f32_32x32x16_bf16 v[144:159], v[60:63], a[124:127], v[144:159]
    buffer_load_dwordx4 v23, s[32:35], s96 offen offset:1024 lds
    v_permlane16_swap_b32 v45, v193
    v_fma_f32 v194, v44, v34, v192
    v_fma_f32 v195, v44, v35, v193
    s_waitcnt lgkmcnt(2)
    v_mfma_f32_32x32x16_bf16 v[128:143], v[48:51], a[128:131], v[128:143]
    s_waitcnt vmcnt(14)
    ds_read_b64_tr_b16 v[56:57], v12 offset:2048
    ds_read_b64_tr_b16 v[58:59], v12 offset:2304
    v_fma_f32 v194, -v45, v35, v194
    v_fmac_f32 v195, v45, v34
    v_mov_b32 v196, v194
    v_mfma_f32_32x32x16_bf16 v[144:159], v[48:51], a[132:135], v[144:159]
    buffer_load_dwordx4 v24, s[32:35], s96 offen offset:2048 lds
    v_mov_b32 v197, v195
    v_cndmask_b32 v42, 0, v44, s[84:85]
    v_cndmask_b32 v43, 0, v45, s[84:85]
    v_permlane32_swap_b32 v194, v196
    s_waitcnt lgkmcnt(2)
    v_mfma_f32_32x32x16_bf16 v[128:143], v[52:55], a[136:139], v[128:143]
    ds_read_b64_tr_b16 v[60:61], v12 offset:3072
    ds_read_b64_tr_b16 v[62:63], v12 offset:3328
    v_permlane32_swap_b32 v195, v197
    v_fma_f32 v208, v194, v216, v196
    v_mfma_f32_32x32x16_bf16 v[144:159], v[52:55], a[140:143], v[144:159]
    buffer_load_dwordx4 v25, s[32:35], s96 offen offset:3072 lds
    v_fma_f32 v210, v194, v217, v197
    v_fma_f32 v208, -v195, v217, v208
    v_fmac_f32 v210, v195, v216
    buffer_store_dwordx4 v[208:211], v171, s[44:47], 0 offen sc1
    ds_write_b32 v169, v170
    s_waitcnt lgkmcnt(3)
    v_mfma_f32_32x32x16_bf16 v[128:143], v[56:59], a[144:147], v[128:143]
    s_waitcnt vmcnt(15)
    ds_read_b64_tr_b16 v[48:49], v12 offset:4096
    ds_read_b64_tr_b16 v[50:51], v12 offset:4352
    v_fma_f32 v198, v194, v34, v44
    v_fma_f32 v199, v194, v35, v45
    v_fma_f32 v198, -v195, v35, v198
    v_mfma_f32_32x32x16_bf16 v[144:159], v[56:59], a[148:151], v[144:159]
    s_add_u32 m0, s6, 20480
    s_add_u32 s96, s64, 114688
    buffer_load_dwordx4 v22, s[32:35], s96 offen offset:0 lds
    v_fmac_f32 v199, v195, v34
    v_cndmask_b32 v42, v42, v194, s[86:87]
    v_cndmask_b32 v43, v43, v195, s[86:87]
    s_waitcnt lgkmcnt(3)
    v_mfma_f32_32x32x16_bf16 v[128:143], v[60:63], a[152:155], v[128:143]
    ds_read_b64_tr_b16 v[52:53], v12 offset:5120
    ds_read_b64_tr_b16 v[54:55], v12 offset:5376
    v_cndmask_b32 v42, v42, v198, s[88:89]
    v_cndmask_b32 v43, v43, v199, s[88:89]
    v_mov_b32 v44, s75
    v_mfma_f32_32x32x16_bf16 v[144:159], v[60:63], a[156:159], v[144:159]
    buffer_load_dwordx4 v23, s[32:35], s96 offen offset:1024 lds
    s_waitcnt lgkmcnt(2)
    v_mfma_f32_32x32x16_bf16 v[128:143], v[48:51], a[160:163], v[128:143]
    s_waitcnt vmcnt(15)
    ds_read_b64_tr_b16 v[56:57], v12 offset:6144
    ds_read_b64_tr_b16 v[58:59], v12 offset:6400
    v_mfma_f32_32x32x16_bf16 v[144:159], v[48:51], a[164:167], v[144:159]
    buffer_load_dwordx4 v24, s[32:35], s96 offen offset:2048 lds
    buffer_load_dwordx4 v25, s[32:35], s96 offen offset:3072 lds
    s_waitcnt lgkmcnt(2)
    v_mfma_f32_32x32x16_bf16 v[128:143], v[52:55], a[168:171], v[128:143]
    ds_read_b64_tr_b16 v[60:61], v12 offset:7168
    ds_read_b64_tr_b16 v[62:63], v12 offset:7424
    v_mfma_f32_32x32x16_bf16 v[144:159], v[52:55], a[172:175], v[144:159]
    s_add_u32 m0, s6, 0
    s_add_u32 s96, s64, 172032
    buffer_load_dwordx4 v22, s[32:35], s96 offen offset:0 lds
    buffer_load_dwordx4 v23, s[32:35], s96 offen offset:1024 lds
    s_waitcnt lgkmcnt(2)
    v_mfma_f32_32x32x16_bf16 v[128:143], v[56:59], a[176:179], v[128:143]
    s_waitcnt vmcnt(17)
    ds_read_b64_tr_b16 v[48:49], v12 offset:8192
    ds_read_b64_tr_b16 v[50:51], v12 offset:8448
    v_mfma_f32_32x32x16_bf16 v[144:159], v[56:59], a[180:183], v[144:159]
    buffer_load_dwordx4 v24, s[32:35], s96 offen offset:2048 lds
    buffer_load_dwordx4 v25, s[32:35], s96 offen offset:3072 lds
    s_waitcnt lgkmcnt(2)
    v_mfma_f32_32x32x16_bf16 v[128:143], v[60:63], a[184:187], v[128:143]
    ds_read_b64_tr_b16 v[52:53], v12 offset:9216
    ds_read_b64_tr_b16 v[54:55], v12 offset:9472
    v_mfma_f32_32x32x16_bf16 v[144:159], v[60:63], a[188:191], v[144:159]
    s_add_u32 m0, s6, 4096
    s_nop 0
    buffer_load_dwordx4 v16, s[20:23], s68 offen offset:0 lds
    buffer_load_dwordx4 v17, s[20:23], s68 offen offset:1024 lds
    s_waitcnt lgkmcnt(2)
    v_mfma_f32_32x32x16_bf16 v[128:143], v[48:51], a[192:195], v[128:143]
    s_waitcnt vmcnt(19)
    ds_read_b64_tr_b16 v[56:57], v12 offset:10240
    ds_read_b64_tr_b16 v[58:59], v12 offset:10496
    v_mfma_f32_32x32x16_bf16 v[144:159], v[48:51], a[196:199], v[144:159]
    buffer_load_dwordx4 v26, s[20:23], s68 offen offset:2048 lds
    buffer_load_dwordx4 v27, s[20:23], s68 offen offset:3072 lds
    s_waitcnt lgkmcnt(2)
    v_mfma_f32_32x32x16_bf16 v[128:143], v[52:55], a[200:203], v[128:143]
    ds_read_b64_tr_b16 v[60:61], v12 offset:11264
    ds_read_b64_tr_b16 v[62:63], v12 offset:11520
    v_mfma_f32_32x32x16_bf16 v[144:159], v[52:55], a[204:207], v[144:159]
    s_waitcnt lgkmcnt(2)
    v_mfma_f32_32x32x16_bf16 v[128:143], v[56:59], a[208:211], v[128:143]
    v_mfma_f32_32x32x16_bf16 v[144:159], v[56:59], a[212:215], v[144:159]
    s_waitcnt lgkmcnt(0)
    v_mfma_f32_32x32x16_bf16 v[128:143], v[60:63], a[216:219], v[128:143]
    v_mfma_f32_32x32x16_bf16 v[144:159], v[60:63], a[220:223], v[144:159]
    s_barrier
    ds_read_b32 v46, v168 offset:0
    ds_read_b32 v47, v168 offset:64
    ds_read_b128 v[176:179], v222 offset:0
    ds_read_b128 v[180:183], v222 offset:16
    ds_read_b128 v[184:187], v222 offset:32
    ds_read_b128 v[188:191], v222 offset:48
    v_mov_b32 v18, s76
    s_mov_b32 m0, s62
    s_add_u32 s97, s59, s2
    buffer_load_dwordx4 v14, s[8:11], s97 offen lds
    buffer_load_dwordx4 v15, s[8:11], s97 offen offset:1024 lds
    v_pk_mul_f32 v[192:193], v[96:97], v[96:97]
    v_pk_mul_f32 v[194:195], v[98:99], v[98:99]
    v_pk_mul_f32 v[196:197], v[100:101], v[100:101]
    v_pk_mul_f32 v[198:199], v[102:103], v[102:103]
    v_pk_fma_f32 v[192:193], v[192:193], v[18:19], v[44:45] op_sel_hi:[1,0,0]
    v_pk_fma_f32 v[194:195], v[194:195], v[18:19], v[44:45] op_sel_hi:[1,0,0]
    v_pk_fma_f32 v[196:197], v[196:197], v[18:19], v[44:45] op_sel_hi:[1,0,0]
    v_pk_fma_f32 v[198:199], v[198:199], v[18:19], v[44:45] op_sel_hi:[1,0,0]
    s_add_u32 m0, s6, 8192
    s_nop 0
    buffer_load_dwordx4 v16, s[24:27], s68 offen offset:0 lds
    v_pk_mul_f32 v[192:193], v[192:193], v[96:97]
    v_pk_mul_f32 v[194:195], v[194:195], v[98:99]
    v_pk_mul_f32 v[196:197], v[196:197], v[100:101]
    v_pk_mul_f32 v[198:199], v[198:199], v[102:103]
    v_exp_f32 v192, v192
    v_exp_f32 v193, v193
    v_exp_f32 v194, v194
    buffer_load_dwordx4 v17, s[24:27], s68 offen offset:1024 lds
    v_exp_f32 v195, v195
    v_exp_f32 v196, v196
    v_exp_f32 v197, v197
    v_exp_f32 v198, v198
    buffer_load_dwordx4 v26, s[24:27], s68 offen offset:2048 lds
    v_exp_f32 v199, v199
    s_waitcnt lgkmcnt(4)
    v_pk_fma_f32 v[192:193], v[192:193], v[46:47], v[46:47] op_sel:[0,0,0] op_sel_hi:[1,0,0]
    v_pk_fma_f32 v[194:195], v[194:195], v[46:47], v[46:47] op_sel:[0,0,0] op_sel_hi:[1,0,0]
    v_pk_fma_f32 v[196:197], v[196:197], v[46:47], v[46:47] op_sel:[0,0,0] op_sel_hi:[1,0,0]
    v_pk_fma_f32 v[198:199], v[198:199], v[46:47], v[46:47] op_sel:[0,0,0] op_sel_hi:[1,0,0]
    v_rcp_f32 v192, v192
    buffer_load_dwordx4 v27, s[24:27], s68 offen offset:3072 lds
    v_rcp_f32 v193, v193
    v_rcp_f32 v194, v194
    v_rcp_f32 v195, v195
    v_rcp_f32 v196, v196
    s_waitcnt vmcnt(25)
    ds_read_b64_tr_b16 a[192:193], v13 offset:12288
    ds_read_b64_tr_b16 a[194:195], v13 offset:12800
    v_rcp_f32 v197, v197
    v_rcp_f32 v198, v198
    v_rcp_f32 v199, v199
    v_pk_mul_f32 v[192:193], v[192:193], v[96:97]
    v_pk_mul_f32 v[194:195], v[194:195], v[98:99]
    v_pk_mul_f32 v[196:197], v[196:197], v[100:101]
    ds_read_b64_tr_b16 a[196:197], v13 offset:13312
    ds_read_b64_tr_b16 a[198:199], v13 offset:13824
    v_pk_mul_f32 v[198:199], v[198:199], v[102:103]
    v_cvt_pk_bf16_f32 v96, v192, v193
    v_cvt_pk_bf16_f32 v97, v194, v195
    v_cvt_pk_bf16_f32 v98, v196, v197
    v_cvt_pk_bf16_f32 v99, v198, v199
    v_pk_mul_f32 v[192:193], v[104:105], v[104:105]
    v_pk_mul_f32 v[194:195], v[106:107], v[106:107]
    v_pk_mul_f32 v[196:197], v[108:109], v[108:109]
    s_waitcnt vmcnt(23)
    ds_read_b64_tr_b16 a[200:201], v13 offset:14336
    ds_read_b64_tr_b16 a[202:203], v13 offset:14848
    v_pk_mul_f32 v[198:199], v[110:111], v[110:111]
    v_pk_fma_f32 v[192:193], v[192:193], v[18:19], v[44:45] op_sel_hi:[1,0,0]
    v_pk_fma_f32 v[194:195], v[194:195], v[18:19], v[44:45] op_sel_hi:[1,0,0]
    v_pk_fma_f32 v[196:197], v[196:197], v[18:19], v[44:45] op_sel_hi:[1,0,0]
    v_pk_fma_f32 v[198:199], v[198:199], v[18:19], v[44:45] op_sel_hi:[1,0,0]
    v_pk_mul_f32 v[192:193], v[192:193], v[104:105]
    v_pk_mul_f32 v[194:195], v[194:195], v[106:107]
    v_pk_mul_f32 v[196:197], v[196:197], v[108:109]
    v_pk_mul_f32 v[198:199], v[198:199], v[110:111]
    s_add_u32 m0, s6, 12288
    s_add_u32 s96, s65, 0
    s_waitcnt lgkmcnt(4)
    buffer_load_dwordx4 v22, s[32:35], s96 offen offset:0 lds
    v_exp_f32 v192, v192
    v_exp_f32 v193, v193
    v_exp_f32 v194, v194
    v_exp_f32 v195, v195
    ds_read_b64_tr_b16 a[204:205], v13 offset:15360
    ds_read_b64_tr_b16 a[206:207], v13 offset:15872
    v_exp_f32 v196, v196
    v_exp_f32 v197, v197
    v_exp_f32 v198, v198
    v_exp_f32 v199, v199
    v_pk_fma_f32 v[192:193], v[192:193], v[46:47], v[46:47] op_sel:[0,0,0] op_sel_hi:[1,0,0]
    s_waitcnt lgkmcnt(4)
    buffer_load_dwordx4 v23, s[32:35], s96 offen offset:1024 lds
    v_pk_fma_f32 v[194:195], v[194:195], v[46:47], v[46:47] op_sel:[0,0,0] op_sel_hi:[1,0,0]
    v_pk_fma_f32 v[196:197], v[196:197], v[46:47], v[46:47] op_sel:[0,0,0] op_sel_hi:[1,0,0]
    v_pk_fma_f32 v[198:199], v[198:199], v[46:47], v[46:47] op_sel:[0,0,0] op_sel_hi:[1,0,0]
    v_rcp_f32 v192, v192
    v_rcp_f32 v193, v193
    v_rcp_f32 v194, v194
    s_waitcnt vmcnt(23)
    ds_read_b64_tr_b16 a[208:209], v13 offset:16384
    ds_read_b64_tr_b16 a[210:211], v13 offset:16896
    v_rcp_f32 v195, v195
    v_rcp_f32 v196, v196
    v_rcp_f32 v197, v197
    v_rcp_f32 v198, v198
    s_waitcnt lgkmcnt(4)
    buffer_load_dwordx4 v24, s[32:35], s96 offen offset:2048 lds
    v_rcp_f32 v199, v199
    v_pk_mul_f32 v[192:193], v[192:193], v[104:105]
    v_pk_mul_f32 v[194:195], v[194:195], v[106:107]
    v_pk_mul_f32 v[196:197], v[196:197], v[108:109]
    v_pk_mul_f32 v[198:199], v[198:199], v[110:111]
    v_cvt_pk_bf16_f32 v104, v192, v193
    v_cvt_pk_bf16_f32 v105, v194, v195
    ds_read_b64_tr_b16 a[212:213], v13 offset:17408
    ds_read_b64_tr_b16 a[214:215], v13 offset:17920
    v_cvt_pk_bf16_f32 v106, v196, v197
    v_cvt_pk_bf16_f32 v107, v198, v199
    v_pk_mul_f32 v[192:193], v[112:113], v[112:113]
    v_pk_mul_f32 v[194:195], v[114:115], v[114:115]
    v_pk_mul_f32 v[196:197], v[116:117], v[116:117]
    v_pk_mul_f32 v[198:199], v[118:119], v[118:119]
    v_pk_fma_f32 v[192:193], v[192:193], v[18:19], v[44:45] op_sel_hi:[1,0,0]
    v_pk_fma_f32 v[194:195], v[194:195], v[18:19], v[44:45] op_sel_hi:[1,0,0]
    v_pk_fma_f32 v[196:197], v[196:197], v[18:19], v[44:45] op_sel_hi:[1,0,0]
    s_waitcnt lgkmcnt(4)
    buffer_load_dwordx4 v25, s[32:35], s96 offen offset:3072 lds
    v_pk_fma_f32 v[198:199], v[198:199], v[18:19], v[44:45] op_sel_hi:[1,0,0]
    v_pk_mul_f32 v[192:193], v[192:193], v[112:113]
    v_pk_mul_f32 v[194:195], v[194:195], v[114:115]
    v_pk_mul_f32 v[196:197], v[196:197], v[116:117]
    v_pk_mul_f32 v[198:199], v[198:199], v[118:119]
    v_exp_f32 v192, v192
    v_exp_f32 v193, v193
    s_waitcnt vmcnt(23)
    ds_read_b64_tr_b16 a[216:217], v13 offset:18432
    ds_read_b64_tr_b16 a[218:219], v13 offset:18944
    v_exp_f32 v194, v194
    v_exp_f32 v195, v195
    v_exp_f32 v196, v196
    v_exp_f32 v197, v197
    s_add_u32 m0, s6, 16384
    s_add_u32 s96, s65, 57344
    s_waitcnt lgkmcnt(4)
    buffer_load_dwordx4 v22, s[32:35], s96 offen offset:0 lds
    v_exp_f32 v198, v198
    v_exp_f32 v199, v199
    v_pk_fma_f32 v[192:193], v[192:193], v[46:47], v[46:47] op_sel:[0,1,1] op_sel_hi:[1,1,1]
    v_pk_fma_f32 v[194:195], v[194:195], v[46:47], v[46:47] op_sel:[0,1,1] op_sel_hi:[1,1,1]
    v_pk_fma_f32 v[196:197], v[196:197], v[46:47], v[46:47] op_sel:[0,1,1] op_sel_hi:[1,1,1]
    v_pk_fma_f32 v[198:199], v[198:199], v[46:47], v[46:47] op_sel:[0,1,1] op_sel_hi:[1,1,1]
    v_rcp_f32 v192, v192
    ds_read_b64_tr_b16 a[220:221], v13 offset:19456
    ds_read_b64_tr_b16 a[222:223], v13 offset:19968
    v_rcp_f32 v193, v193
    v_rcp_f32 v194, v194
    v_rcp_f32 v195, v195
    v_rcp_f32 v196, v196
    s_waitcnt lgkmcnt(4)
    buffer_load_dwordx4 v23, s[32:35], s96 offen offset:1024 lds
    v_rcp_f32 v197, v197
    v_rcp_f32 v198, v198
    v_rcp_f32 v199, v199
    v_pk_mul_f32 v[192:193], v[192:193], v[112:113]
    v_pk_mul_f32 v[194:195], v[194:195], v[114:115]
    s_waitcnt vmcnt(22)
    ds_read_b64_tr_b16 a[224:225], v13 offset:20480
    ds_read_b64_tr_b16 a[226:227], v13 offset:20992
    v_pk_mul_f32 v[196:197], v[196:197], v[116:117]
    v_pk_mul_f32 v[198:199], v[198:199], v[118:119]
    v_cvt_pk_bf16_f32 v112, v192, v193
    v_cvt_pk_bf16_f32 v113, v194, v195
    v_cvt_pk_bf16_f32 v114, v196, v197
    v_cvt_pk_bf16_f32 v115, v198, v199
    v_pk_mul_f32 v[192:193], v[120:121], v[120:121]
    v_pk_mul_f32 v[194:195], v[122:123], v[122:123]
    s_waitcnt lgkmcnt(4)
    buffer_load_dwordx4 v24, s[32:35], s96 offen offset:2048 lds
    v_pk_mul_f32 v[196:197], v[124:125], v[124:125]
    v_pk_mul_f32 v[198:199], v[126:127], v[126:127]
    v_pk_fma_f32 v[192:193], v[192:193], v[18:19], v[44:45] op_sel_hi:[1,0,0]
    v_pk_fma_f32 v[194:195], v[194:195], v[18:19], v[44:45] op_sel_hi:[1,0,0]
    v_pk_fma_f32 v[196:197], v[196:197], v[18:19], v[44:45] op_sel_hi:[1,0,0]
    v_pk_fma_f32 v[198:199], v[198:199], v[18:19], v[44:45] op_sel_hi:[1,0,0]
    v_pk_mul_f32 v[192:193], v[192:193], v[120:121]
    v_pk_mul_f32 v[194:195], v[194:195], v[122:123]
    v_pk_mul_f32 v[196:197], v[196:197], v[124:125]
    ds_read_b64_tr_b16 a[228:229], v13 offset:21504
    ds_read_b64_tr_b16 a[230:231], v13 offset:22016
    v_pk_mul_f32 v[198:199], v[198:199], v[126:127]
    v_exp_f32 v192, v192
    v_exp_f32 v193, v193
    v_exp_f32 v194, v194
    v_exp_f32 v195, v195
    s_waitcnt lgkmcnt(4)
    buffer_load_dwordx4 v25, s[32:35], s96 offen offset:3072 lds
    v_exp_f32 v196, v196
    v_exp_f32 v197, v197
    v_exp_f32 v198, v198
    v_exp_f32 v199, v199
    s_waitcnt vmcnt(22)
    ds_read_b64_tr_b16 a[232:233], v13 offset:22528
    ds_read_b64_tr_b16 a[234:235], v13 offset:23040
    v_pk_fma_f32 v[192:193], v[192:193], v[46:47], v[46:47] op_sel:[0,1,1] op_sel_hi:[1,1,1]
    v_pk_fma_f32 v[194:195], v[194:195], v[46:47], v[46:47] op_sel:[0,1,1] op_sel_hi:[1,1,1]
    v_pk_fma_f32 v[196:197], v[196:197], v[46:47], v[46:47] op_sel:[0,1,1] op_sel_hi:[1,1,1]
    v_pk_fma_f32 v[198:199], v[198:199], v[46:47], v[46:47] op_sel:[0,1,1] op_sel_hi:[1,1,1]
    v_rcp_f32 v192, v192
    v_rcp_f32 v193, v193
    s_add_u32 m0, s6, 20480
    s_add_u32 s96, s65, 114688
    s_waitcnt lgkmcnt(4)
    buffer_load_dwordx4 v22, s[32:35], s96 offen offset:0 lds
    v_rcp_f32 v194, v194
    v_rcp_f32 v195, v195
    v_rcp_f32 v196, v196
    v_rcp_f32 v197, v197
    v_rcp_f32 v198, v198
    ds_read_b64_tr_b16 a[236:237], v13 offset:23552
    ds_read_b64_tr_b16 a[238:239], v13 offset:24064
    v_rcp_f32 v199, v199
    v_pk_mul_f32 v[192:193], v[192:193], v[120:121]
    v_pk_mul_f32 v[194:195], v[194:195], v[122:123]
    v_pk_mul_f32 v[196:197], v[196:197], v[124:125]
    v_pk_mul_f32 v[198:199], v[198:199], v[126:127]
    v_cvt_pk_bf16_f32 v120, v192, v193
    s_waitcnt lgkmcnt(4)
    buffer_load_dwordx4 v23, s[32:35], s96 offen offset:1024 lds
    v_cvt_pk_bf16_f32 v121, v194, v195
    v_cvt_pk_bf16_f32 v122, v196, v197
    v_cvt_pk_bf16_f32 v123, v198, v199
    v_pk_mul_f32 v[192:193], v[128:129], v[128:129]
    v_pk_mul_f32 v[194:195], v[130:131], v[130:131]
    v_pk_mul_f32 v[196:197], v[132:133], v[132:133]
    v_pk_mul_f32 v[198:199], v[134:135], v[134:135]
    v_pk_fma_f32 v[192:193], v[192:193], v[18:19], v[44:45] op_sel_hi:[1,0,0]
    v_pk_fma_f32 v[194:195], v[194:195], v[18:19], v[44:45] op_sel_hi:[1,0,0]
    s_waitcnt vmcnt(22)
    ds_read_b64_tr_b16 a[240:241], v13 offset:0
    ds_read_b64_tr_b16 a[242:243], v13 offset:512
    v_pk_fma_f32 v[196:197], v[196:197], v[18:19], v[44:45] op_sel_hi:[1,0,0]
    v_pk_fma_f32 v[198:199], v[198:199], v[18:19], v[44:45] op_sel_hi:[1,0,0]
    v_pk_mul_f32 v[192:193], v[192:193], v[128:129]
    v_pk_mul_f32 v[194:195], v[194:195], v[130:131]
    v_pk_mul_f32 v[196:197], v[196:197], v[132:133]
    v_pk_mul_f32 v[198:199], v[198:199], v[134:135]
    v_exp_f32 v192, v192
    s_waitcnt lgkmcnt(4)
    buffer_load_dwordx4 v24, s[32:35], s96 offen offset:2048 lds
    v_exp_f32 v193, v193
    v_exp_f32 v194, v194
    v_exp_f32 v195, v195
    v_exp_f32 v196, v196
    v_exp_f32 v197, v197
    ds_read_b64_tr_b16 a[244:245], v13 offset:1024
    ds_read_b64_tr_b16 a[246:247], v13 offset:1536
    v_exp_f32 v198, v198
    v_exp_f32 v199, v199
    v_pk_fma_f32 v[192:193], v[192:193], v[46:47], v[46:47] op_sel:[0,0,0] op_sel_hi:[1,0,0]
    v_pk_fma_f32 v[194:195], v[194:195], v[46:47], v[46:47] op_sel:[0,0,0] op_sel_hi:[1,0,0]
    v_pk_fma_f32 v[196:197], v[196:197], v[46:47], v[46:47] op_sel:[0,0,0] op_sel_hi:[1,0,0]
    v_pk_fma_f32 v[198:199], v[198:199], v[46:47], v[46:47] op_sel:[0,0,0] op_sel_hi:[1,0,0]
    s_waitcnt lgkmcnt(4)
    buffer_load_dwordx4 v25, s[32:35], s96 offen offset:3072 lds
    v_rcp_f32 v192, v192
    v_rcp_f32 v193, v193
    v_rcp_f32 v194, v194
    v_rcp_f32 v195, v195
    s_waitcnt vmcnt(22)
    ds_read_b64_tr_b16 a[248:249], v13 offset:2048
    ds_read_b64_tr_b16 a[250:251], v13 offset:2560
    v_rcp_f32 v196, v196
    v_rcp_f32 v197, v197
    v_rcp_f32 v198, v198
    v_rcp_f32 v199, v199
    v_pk_mul_f32 v[192:193], v[192:193], v[128:129]
    s_add_u32 m0, s6, 0
    s_add_u32 s96, s65, 172032
    s_waitcnt lgkmcnt(4)
    buffer_load_dwordx4 v22, s[32:35], s96 offen offset:0 lds
    v_pk_mul_f32 v[194:195], v[194:195], v[130:131]
    v_pk_mul_f32 v[196:197], v[196:197], v[132:133]
    v_pk_mul_f32 v[198:199], v[198:199], v[134:135]
    v_cvt_pk_bf16_f32 v128, v192, v193
    v_cvt_pk_bf16_f32 v129, v194, v195
    v_cvt_pk_bf16_f32 v130, v196, v197
    v_cvt_pk_bf16_f32 v131, v198, v199
    v_pk_mul_f32 v[192:193], v[136:137], v[136:137]
    ds_read_b64_tr_b16 a[252:253], v13 offset:3072
    ds_read_b64_tr_b16 a[254:255], v13 offset:3584
    v_pk_mul_f32 v[194:195], v[138:139], v[138:139]
    v_pk_mul_f32 v[196:197], v[140:141], v[140:141]
    v_pk_mul_f32 v[198:199], v[142:143], v[142:143]
    v_pk_fma_f32 v[192:193], v[192:193], v[18:19], v[44:45] op_sel_hi:[1,0,0]
    v_pk_fma_f32 v[194:195], v[194:195], v[18:19], v[44:45] op_sel_hi:[1,0,0]
    v_pk_fma_f32 v[196:197], v[196:197], v[18:19], v[44:45] op_sel_hi:[1,0,0]
    v_pk_fma_f32 v[198:199], v[198:199], v[18:19], v[44:45] op_sel_hi:[1,0,0]
    v_pk_mul_f32 v[192:193], v[192:193], v[136:137]
    v_pk_mul_f32 v[194:195], v[194:195], v[138:139]
    s_waitcnt lgkmcnt(4)
    buffer_load_dwordx4 v23, s[32:35], s96 offen offset:1024 lds
    v_pk_mul_f32 v[196:197], v[196:197], v[140:141]
    v_pk_mul_f32 v[198:199], v[198:199], v[142:143]
    v_exp_f32 v192, v192
    v_exp_f32 v193, v193
    v_exp_f32 v194, v194
    s_waitcnt lgkmcnt(2)
    buffer_load_dwordx4 v24, s[32:35], s96 offen offset:2048 lds
    v_exp_f32 v195, v195
    v_exp_f32 v196, v196
    v_exp_f32 v197, v197
    v_exp_f32 v198, v198
    v_exp_f32 v199, v199
    s_waitcnt lgkmcnt(0)
    buffer_load_dwordx4 v25, s[32:35], s96 offen offset:3072 lds
    v_pk_fma_f32 v[192:193], v[192:193], v[46:47], v[46:47] op_sel:[0,0,0] op_sel_hi:[1,0,0]
    v_pk_fma_f32 v[194:195], v[194:195], v[46:47], v[46:47] op_sel:[0,0,0] op_sel_hi:[1,0,0]
    v_pk_fma_f32 v[196:197], v[196:197], v[46:47], v[46:47] op_sel:[0,0,0] op_sel_hi:[1,0,0]
    v_pk_fma_f32 v[198:199], v[198:199], v[46:47], v[46:47] op_sel:[0,0,0] op_sel_hi:[1,0,0]
    v_rcp_f32 v192, v192
    v_rcp_f32 v193, v193
    v_rcp_f32 v194, v194
    v_rcp_f32 v195, v195
    v_rcp_f32 v196, v196
    v_rcp_f32 v197, v197
    v_rcp_f32 v198, v198
    v_rcp_f32 v199, v199
    v_pk_mul_f32 v[192:193], v[192:193], v[136:137]
    v_pk_mul_f32 v[194:195], v[194:195], v[138:139]
    v_pk_mul_f32 v[196:197], v[196:197], v[140:141]
    v_pk_mul_f32 v[198:199], v[198:199], v[142:143]
    v_cvt_pk_bf16_f32 v136, v192, v193
    v_cvt_pk_bf16_f32 v137, v194, v195
    v_cvt_pk_bf16_f32 v138, v196, v197
    v_cvt_pk_bf16_f32 v139, v198, v199
    buffer_load_dwordx4 v[224:227], v2, s[44:47], 0 offen offset:0 sc1
    buffer_load_dwordx4 v[228:231], v2, s[44:47], 0 offen offset:256 sc1
    buffer_load_dwordx4 v[232:235], v2, s[44:47], 0 offen offset:512 sc1
    buffer_load_dwordx4 v[236:239], v2, s[44:47], 0 offen offset:768 sc1
    buffer_load_dwordx4 v[240:243], v2, s[44:47], 0 offen offset:1024 sc1
    buffer_load_dwordx4 v[244:247], v2, s[44:47], 0 offen offset:1280 sc1
    buffer_load_dwordx4 v[248:251], v2, s[44:47], 0 offen offset:1536 sc1
    buffer_load_dwordx4 v[252:255], v2, s[44:47], 0 offen offset:1792 sc1
    buffer_load_dword v208, v167, s[36:39], s93 offen sc1
    v_pk_mul_f32 v[192:193], v[144:145], v[144:145]
    v_pk_mul_f32 v[194:195], v[146:147], v[146:147]
    v_pk_mul_f32 v[196:197], v[148:149], v[148:149]
    v_pk_mul_f32 v[198:199], v[150:151], v[150:151]
    v_pk_fma_f32 v[192:193], v[192:193], v[18:19], v[44:45] op_sel_hi:[1,0,0]
    v_pk_fma_f32 v[194:195], v[194:195], v[18:19], v[44:45] op_sel_hi:[1,0,0]
    v_pk_fma_f32 v[196:197], v[196:197], v[18:19], v[44:45] op_sel_hi:[1,0,0]
    v_pk_fma_f32 v[198:199], v[198:199], v[18:19], v[44:45] op_sel_hi:[1,0,0]
    v_pk_mul_f32 v[192:193], v[192:193], v[144:145]
    v_pk_mul_f32 v[194:195], v[194:195], v[146:147]
    v_pk_mul_f32 v[196:197], v[196:197], v[148:149]
    v_pk_mul_f32 v[198:199], v[198:199], v[150:151]
    v_exp_f32 v192, v192
    v_exp_f32 v193, v193
    v_exp_f32 v194, v194
    v_exp_f32 v195, v195
    v_exp_f32 v196, v196
    v_exp_f32 v197, v197
    v_exp_f32 v198, v198
    v_exp_f32 v199, v199
    v_pk_fma_f32 v[192:193], v[192:193], v[46:47], v[46:47] op_sel:[0,1,1] op_sel_hi:[1,1,1]
    v_pk_fma_f32 v[194:195], v[194:195], v[46:47], v[46:47] op_sel:[0,1,1] op_sel_hi:[1,1,1]
    v_pk_fma_f32 v[196:197], v[196:197], v[46:47], v[46:47] op_sel:[0,1,1] op_sel_hi:[1,1,1]
    v_pk_fma_f32 v[198:199], v[198:199], v[46:47], v[46:47] op_sel:[0,1,1] op_sel_hi:[1,1,1]
    v_rcp_f32 v192, v192
    v_rcp_f32 v193, v193
    v_rcp_f32 v194, v194
    v_rcp_f32 v195, v195
    v_rcp_f32 v196, v196
    v_rcp_f32 v197, v197
    v_rcp_f32 v198, v198
    v_rcp_f32 v199, v199
    v_pk_mul_f32 v[192:193], v[192:193], v[144:145]
    v_pk_mul_f32 v[194:195], v[194:195], v[146:147]
    v_pk_mul_f32 v[196:197], v[196:197], v[148:149]
    v_pk_mul_f32 v[198:199], v[198:199], v[150:151]
    v_cvt_pk_bf16_f32 v144, v192, v193
    v_cvt_pk_bf16_f32 v145, v194, v195
    v_cvt_pk_bf16_f32 v146, v196, v197
    v_cvt_pk_bf16_f32 v147, v198, v199
    v_pk_mul_f32 v[192:193], v[152:153], v[152:153]
    v_pk_mul_f32 v[194:195], v[154:155], v[154:155]
    v_pk_mul_f32 v[196:197], v[156:157], v[156:157]
    ds_write_b128 v29, v[96:99] offset:0
    v_pk_mul_f32 v[198:199], v[158:159], v[158:159]
    v_pk_fma_f32 v[192:193], v[192:193], v[18:19], v[44:45] op_sel_hi:[1,0,0]
    v_pk_fma_f32 v[194:195], v[194:195], v[18:19], v[44:45] op_sel_hi:[1,0,0]
    v_pk_fma_f32 v[196:197], v[196:197], v[18:19], v[44:45] op_sel_hi:[1,0,0]
    v_pk_fma_f32 v[198:199], v[198:199], v[18:19], v[44:45] op_sel_hi:[1,0,0]
    v_pk_mul_f32 v[192:193], v[192:193], v[152:153]
    v_pk_mul_f32 v[194:195], v[194:195], v[154:155]
    v_pk_mul_f32 v[196:197], v[196:197], v[156:157]
    ds_write_b128 v29, v[104:107] offset:2048
    v_pk_mul_f32 v[198:199], v[198:199], v[158:159]
    v_exp_f32 v192, v192
    v_exp_f32 v193, v193
    v_exp_f32 v194, v194
    v_exp_f32 v195, v195
    ds_write_b128 v29, v[112:115] offset:1024
    v_exp_f32 v196, v196
    v_exp_f32 v197, v197
    v_exp_f32 v198, v198
    v_exp_f32 v199, v199
    ds_write_b128 v29, v[120:123] offset:3072
    v_pk_fma_f32 v[192:193], v[192:193], v[46:47], v[46:47] op_sel:[0,1,1] op_sel_hi:[1,1,1]
    v_pk_fma_f32 v[194:195], v[194:195], v[46:47], v[46:47] op_sel:[0,1,1] op_sel_hi:[1,1,1]
    v_pk_fma_f32 v[196:197], v[196:197], v[46:47], v[46:47] op_sel:[0,1,1] op_sel_hi:[1,1,1]
    v_pk_fma_f32 v[198:199], v[198:199], v[46:47], v[46:47] op_sel:[0,1,1] op_sel_hi:[1,1,1]
    v_rcp_f32 v192, v192
    v_rcp_f32 v193, v193
    ds_write_b128 v175, v[128:131] offset:0
    v_rcp_f32 v194, v194
    v_rcp_f32 v195, v195
    v_rcp_f32 v196, v196
    v_rcp_f32 v197, v197
    ds_write_b128 v175, v[136:139] offset:2048
    v_rcp_f32 v198, v198
    v_rcp_f32 v199, v199
    v_pk_mul_f32 v[192:193], v[192:193], v[152:153]
    v_pk_mul_f32 v[194:195], v[194:195], v[154:155]
    v_pk_mul_f32 v[196:197], v[196:197], v[156:157]
    v_pk_mul_f32 v[198:199], v[198:199], v[158:159]
    ds_write_b128 v175, v[144:147] offset:1024
    v_cvt_pk_bf16_f32 v152, v192, v193
    v_cvt_pk_bf16_f32 v153, v194, v195
    v_cvt_pk_bf16_f32 v154, v196, v197
    v_cvt_pk_bf16_f32 v155, v198, v199
    s_waitcnt vmcnt(8)
    v_bitop3_b32 v213, v225, v227, s7 bitop3:0x7e
    v_min_u32 v212, 1, v213
    s_waitcnt vmcnt(7)
    v_bitop3_b32 v213, v229, v231, s7 bitop3:0x7e
    v_min_u32 v213, 1, v213
    ds_write_b128 v175, v[152:155] offset:3072
    v_lshl_or_b32 v212, v212, 1, v213
    s_waitcnt vmcnt(6)
    v_bitop3_b32 v213, v233, v235, s7 bitop3:0x7e
    v_min_u32 v213, 1, v213
    v_lshl_or_b32 v212, v212, 1, v213
    s_waitcnt vmcnt(5)
    v_bitop3_b32 v213, v237, v239, s7 bitop3:0x7e
    v_min_u32 v213, 1, v213
    v_lshl_or_b32 v212, v212, 1, v213
    s_waitcnt vmcnt(4)
    v_bitop3_b32 v213, v241, v243, s7 bitop3:0x7e
    v_min_u32 v213, 1, v213
    v_lshl_or_b32 v212, v212, 1, v213
    s_waitcnt vmcnt(3)
    v_bitop3_b32 v213, v245, v247, s7 bitop3:0x7e
    v_min_u32 v213, 1, v213
    v_lshl_or_b32 v212, v212, 1, v213
    s_waitcnt vmcnt(2)
    v_bitop3_b32 v213, v249, v251, s7 bitop3:0x7e
    v_min_u32 v213, 1, v213
    v_lshl_or_b32 v212, v212, 1, v213
    s_waitcnt vmcnt(1)
    v_bitop3_b32 v213, v253, v255, s7 bitop3:0x7e
    v_min_u32 v213, 1, v213
    v_lshl_or_b32 v212, v212, 1, v213
    v_and_b32 v212, v212, v3
    v_cmp_ne_u32 vcc, 0, v212
    s_nop 3
    s_cbranch_vccnz L_lb_retry
L_lb_ok:
    v_fma_f32 v248, v252, v36, v248
    v_fma_f32 v250, v252, v37, v250
    v_fma_f32 v248, -v254, v37, v248
    v_fmac_f32 v250, v254, v36
    v_fma_f32 v244, v248, v36, v244
    v_fma_f32 v246, v248, v37, v246
    v_fma_f32 v244, -v250, v37, v244
    v_fmac_f32 v246, v250, v36
    v_fma_f32 v240, v244, v36, v240
    v_fma_f32 v242, v244, v37, v242
    v_fma_f32 v240, -v246, v37, v240
    v_fmac_f32 v242, v246, v36
    v_fma_f32 v236, v240, v36, v236
    v_fma_f32 v238, v240, v37, v238
    v_fma_f32 v236, -v242, v37, v236
    v_fmac_f32 v238, v242, v36
    v_fma_f32 v232, v236, v36, v232
    v_fma_f32 v234, v236, v37, v234
    v_fma_f32 v232, -v238, v37, v232
    v_fmac_f32 v234, v238, v36
    v_fma_f32 v228, v232, v36, v228
    v_fma_f32 v230, v232, v37, v230
    v_fma_f32 v228, -v234, v37, v228
    v_fmac_f32 v230, v234, v36
    v_fma_f32 v224, v228, v36, v224
    v_fma_f32 v226, v228, v37, v226
    v_fma_f32 v224, -v230, v37, v224
    v_fmac_f32 v226, v230, v36
    v_mul_f32 v194, v224, v40
    v_mul_f32 v195, v224, v41
    v_fma_f32 v194, -v226, v41, v194
    v_fmac_f32 v195, v226, v40
    v_mov_b32 v196, v194
    v_mov_b32 v197, v195
    s_nop 0
    v_permlane16_swap_b32 v194, v196
    v_permlane16_swap_b32 v195, v197
    v_add_f32 v194, v194, v196
    v_add_f32 v195, v195, v197
    v_mov_b32 v196, v194
    v_mov_b32 v197, v195
    s_nop 0
    v_permlane32_swap_b32 v194, v196
    v_permlane32_swap_b32 v195, v197
    v_add_f32 v194, v194, v196
    v_add_f32 v195, v195, v197
    v_fma_f32 v42, v194, v38, v42
    v_fma_f32 v43, v194, v39, v43
    v_fma_f32 v42, -v195, v39, v42
    v_fmac_f32 v43, v195, v38
    v_fma_f32 v64, v42, v30, v64
    v_fma_f32 v80, v42, v31, v80
    v_fma_f32 v64, -v43, v31, v64
    v_fmac_f32 v80, v43, v30
    v_fma_f32 v65, v64, v30, v65
    v_fma_f32 v81, v64, v31, v81
    v_fma_f32 v65, -v80, v31, v65
    v_fmac_f32 v81, v80, v30
    v_pk_mul_f32 v[192:193], v[64:65], v[176:177]
    v_pk_mul_f32 v[194:195], v[80:81], v[176:177] neg_lo:[1,0] neg_hi:[1,0]
    v_cvt_pk_bf16_f32 v224, v192, v193
    v_cvt_pk_bf16_f32 v232, v194, v195
    v_fma_f32 v66, v65, v30, v66
    v_fma_f32 v82, v65, v31, v82
    v_fma_f32 v66, -v81, v31, v66
    v_fmac_f32 v82, v81, v30
    v_fma_f32 v67, v66, v30, v67
    v_fma_f32 v83, v66, v31, v83
    v_fma_f32 v67, -v82, v31, v67
    v_fmac_f32 v83, v82, v30
    v_pk_mul_f32 v[192:193], v[66:67], v[178:179]
    v_pk_mul_f32 v[194:195], v[82:83], v[178:179] neg_lo:[1,0] neg_hi:[1,0]
    v_cvt_pk_bf16_f32 v225, v192, v193
    v_cvt_pk_bf16_f32 v233, v194, v195
    v_fma_f32 v68, v67, v30, v68
    v_fma_f32 v84, v67, v31, v84
    v_fma_f32 v68, -v83, v31, v68
    v_fmac_f32 v84, v83, v30
    v_fma_f32 v69, v68, v30, v69
    v_fma_f32 v85, v68, v31, v85
    v_fma_f32 v69, -v84, v31, v69
    v_fmac_f32 v85, v84, v30
    v_pk_mul_f32 v[192:193], v[68:69], v[180:181]
    v_pk_mul_f32 v[194:195], v[84:85], v[180:181] neg_lo:[1,0] neg_hi:[1,0]
    v_cvt_pk_bf16_f32 v226, v192, v193
    v_cvt_pk_bf16_f32 v234, v194, v195
    v_fma_f32 v70, v69, v30, v70
    v_fma_f32 v86, v69, v31, v86
    v_fma_f32 v70, -v85, v31, v70
    v_fmac_f32 v86, v85, v30
    v_fma_f32 v71, v70, v30, v71
    v_fma_f32 v87, v70, v31, v87
    v_fma_f32 v71, -v86, v31, v71
    v_fmac_f32 v87, v86, v30
    v_pk_mul_f32 v[192:193], v[70:71], v[182:183]
    v_pk_mul_f32 v[194:195], v[86:87], v[182:183] neg_lo:[1,0] neg_hi:[1,0]
    v_cvt_pk_bf16_f32 v227, v192, v193
    v_cvt_pk_bf16_f32 v235, v194, v195
    ds_write_b128 v160, v[224:227] offset:0
    v_fma_f32 v72, v71, v30, v72
    v_fma_f32 v88, v71, v31, v88
    v_fma_f32 v72, -v87, v31, v72
    v_fmac_f32 v88, v87, v30
    v_fma_f32 v73, v72, v30, v73
    v_fma_f32 v89, v72, v31, v89
    v_fma_f32 v73, -v88, v31, v73
    v_fmac_f32 v89, v88, v30
    ds_write_b128 v160, v[232:235] offset:2048
    v_pk_mul_f32 v[192:193], v[72:73], v[184:185]
    v_pk_mul_f32 v[194:195], v[88:89], v[184:185] neg_lo:[1,0] neg_hi:[1,0]
    v_cvt_pk_bf16_f32 v228, v192, v193
    v_cvt_pk_bf16_f32 v236, v194, v195
    v_fma_f32 v74, v73, v30, v74
    v_fma_f32 v90, v73, v31, v90
    v_fma_f32 v74, -v89, v31, v74
    v_fmac_f32 v90, v89, v30
    v_fma_f32 v75, v74, v30, v75
    v_fma_f32 v91, v74, v31, v91
    v_fma_f32 v75, -v90, v31, v75
    v_fmac_f32 v91, v90, v30
    v_pk_mul_f32 v[192:193], v[74:75], v[186:187]
    v_pk_mul_f32 v[194:195], v[90:91], v[186:187] neg_lo:[1,0] neg_hi:[1,0]
    v_cvt_pk_bf16_f32 v229, v192, v193
    v_cvt_pk_bf16_f32 v237, v194, v195
    v_fma_f32 v76, v75, v30, v76
    v_fma_f32 v92, v75, v31, v92
    v_fma_f32 v76, -v91, v31, v76
    v_fmac_f32 v92, v91, v30
    v_fma_f32 v77, v76, v30, v77
    v_fma_f32 v93, v76, v31, v93
    v_fma_f32 v77, -v92, v31, v77
    v_fmac_f32 v93, v92, v30
    v_pk_mul_f32 v[192:193], v[76:77], v[188:189]
    v_pk_mul_f32 v[194:195], v[92:93], v[188:189] neg_lo:[1,0] neg_hi:[1,0]
    v_cvt_pk_bf16_f32 v230, v192, v193
    v_cvt_pk_bf16_f32 v238, v194, v195
    v_fma_f32 v78, v77, v30, v78
    v_fma_f32 v94, v77, v31, v94
    v_fma_f32 v78, -v93, v31, v78
    v_fmac_f32 v94, v93, v30
    v_fma_f32 v79, v78, v30, v79
    v_fma_f32 v95, v78, v31, v95
    v_fma_f32 v79, -v94, v31, v79
    v_fmac_f32 v95, v94, v30
    v_pk_mul_f32 v[192:193], v[78:79], v[190:191]
    v_pk_mul_f32 v[194:195], v[94:95], v[190:191] neg_lo:[1,0] neg_hi:[1,0]
    v_cvt_pk_bf16_f32 v231, v192, v193
    v_cvt_pk_bf16_f32 v239, v194, v195
    ds_write_b128 v161, v[228:231] offset:0
    ds_write_b128 v161, v[236:239] offset:2048
    v_mov_b32 v221, s7
    s_waitcnt lgkmcnt(0)
    s_barrier
    ds_read_b128 a[0:3], v28 offset:8192
    ds_read_b128 a[4:7], v28 offset:9216
    ds_read_b128 a[8:11], v28 offset:10240
    ds_read_b128 a[12:15], v28 offset:11264
    ds_read_b128 a[16:19], v28 offset:12288
    ds_read_b128 a[20:23], v28 offset:13312
    s_waitcnt lgkmcnt(5)
    v_mfma_f32_32x32x16_bf16 v[96:111], a[0:3], a[192:195], 0
    ds_read_b128 a[24:27], v28 offset:14336
    ds_read_b128 a[28:31], v28 offset:15360
    s_waitcnt lgkmcnt(6)
    v_mfma_f32_32x32x16_bf16 v[112:127], a[4:7], a[192:195], 0
    ds_read_b128 v[64:67], v8 offset:4096
    ds_read_b64_tr_b16 a[192:193], v13 offset:12288
    ds_read_b64_tr_b16 a[194:195], v13 offset:12800
    s_waitcnt lgkmcnt(8)
    v_mfma_f32_32x32x16_bf16 v[96:111], a[8:11], a[196:199], v[96:111]
    ds_read_b128 a[32:35], v28 offset:16384
    ds_read_b128 a[36:39], v28 offset:17408
    s_add_u32 s98, s3, 1
    s_cmp_ge_u32 s98, 7
    s_cselect_b32 s99, 7, 0
    s_sub_u32 s98, s98, s99
    s_lshl_b32 s98, s98, 13
    s_add_u32 s52, s98, s83
    s_waitcnt lgkmcnt(9)
    v_mfma_f32_32x32x16_bf16 v[112:127], a[12:15], a[196:199], v[112:127]
    ds_read_b128 v[68:71], v9 offset:4096
    ds_read_b64_tr_b16 a[196:197], v13 offset:13312
    ds_read_b64_tr_b16 a[198:199], v13 offset:13824
    s_add_u32 s98, s3, 2
    s_waitcnt lgkmcnt(11)
    v_mfma_f32_32x32x16_bf16 v[96:111], a[16:19], a[200:203], v[96:111]
    ds_read_b128 a[40:43], v28 offset:18432
    ds_read_b128 a[44:47], v28 offset:19456
    s_cmp_ge_u32 s98, 7
    s_cselect_b32 s99, 7, 0
    s_sub_u32 s98, s98, s99
    s_lshl_b32 s98, s98, 13
    s_add_u32 s53, s98, s83
    s_waitcnt lgkmcnt(12)
    v_mfma_f32_32x32x16_bf16 v[112:127], a[20:23], a[200:203], v[112:127]
    ds_read_b128 v[72:75], v10 offset:4096
    ds_read_b64_tr_b16 a[200:201], v13 offset:14336
    ds_read_b64_tr_b16 a[202:203], v13 offset:14848
    s_add_u32 m0, s6, 12288
    s_add_u32 s96, s66, 0
    s_waitcnt lgkmcnt(10)
    buffer_load_dwordx4 v22, s[32:35], s96 offen offset:0 lds
    v_mfma_f32_32x32x16_bf16 v[96:111], a[24:27], a[204:207], v[96:111]
    ds_read_b128 a[48:51], v28 offset:20480
    ds_read_b128 a[52:55], v28 offset:21504
    s_add_u32 s98, s3, 3
    s_cmp_ge_u32 s98, 7
    s_cselect_b32 s99, 7, 0
    s_sub_u32 s98, s98, s99
    v_mfma_f32_32x32x16_bf16 v[112:127], a[28:31], a[204:207], v[112:127]
    ds_read_b128 v[76:79], v11 offset:4096
    ds_read_b64_tr_b16 a[204:205], v13 offset:15360
    ds_read_b64_tr_b16 a[206:207], v13 offset:15872
    s_waitcnt lgkmcnt(10)
    buffer_load_dwordx4 v23, s[32:35], s96 offen offset:1024 lds
    v_mfma_f32_32x32x16_bf16 v[96:111], a[32:35], a[208:211], v[96:111]
    ds_read_b128 a[56:59], v28 offset:22528
    ds_read_b128 a[60:63], v28 offset:23552
    s_lshl_b32 s98, s98, 13
    s_add_u32 s54, s98, s83
    s_add_u32 s98, s3, 4
    s_cmp_ge_u32 s98, 7
    s_cselect_b32 s99, 7, 0
    v_mfma_f32_32x32x16_bf16 v[112:127], a[36:39], a[208:211], v[112:127]
    ds_read_b128 v[80:83], v8 offset:8192
    ds_read_b64_tr_b16 a[208:209], v13 offset:16384
    ds_read_b64_tr_b16 a[210:211], v13 offset:16896
    s_waitcnt lgkmcnt(10)
    buffer_load_dwordx4 v24, s[32:35], s96 offen offset:2048 lds
    v_mfma_f32_32x32x16_bf16 v[96:111], a[40:43], a[212:215], v[96:111]
    ds_read_b128 a[64:67], v28 offset:24576
    ds_read_b128 a[68:71], v28 offset:25600
    s_sub_u32 s98, s98, s99
    s_lshl_b32 s98, s98, 13
    s_add_u32 s55, s98, s83
    s_add_u32 s98, s3, 5
    v_mfma_f32_32x32x16_bf16 v[112:127], a[44:47], a[212:215], v[112:127]
    ds_read_b128 v[84:87], v9 offset:8192
    ds_read_b64_tr_b16 a[212:213], v13 offset:17408
    ds_read_b64_tr_b16 a[214:215], v13 offset:17920
    s_add_u32 m0, s6, 4096
    s_waitcnt lgkmcnt(12)
    buffer_load_dwordx4 v16, s[20:23], s69 offen offset:0 lds
    buffer_load_dwordx4 v17, s[20:23], s69 offen offset:1024 lds
    v_mfma_f32_32x32x16_bf16 v[96:111], a[48:51], a[216:219], v[96:111]
    ds_read_b128 a[72:75], v28 offset:26624
    ds_read_b128 a[76:79], v28 offset:27648
    s_cmp_ge_u32 s98, 7
    s_cselect_b32 s99, 7, 0
    s_sub_u32 s98, s98, s99
    s_lshl_b32 s98, s98, 13
    v_mfma_f32_32x32x16_bf16 v[112:127], a[52:55], a[216:219], v[112:127]
    ds_read_b128 v[88:91], v10 offset:8192
    ds_read_b64_tr_b16 a[216:217], v13 offset:18432
    ds_read_b64_tr_b16 a[218:219], v13 offset:18944
    buffer_load_dwordx4 v26, s[20:23], s69 offen offset:2048 lds
    buffer_load_dwordx4 v27, s[20:23], s69 offen offset:3072 lds
    s_waitcnt lgkmcnt(14)
    v_mfma_f32_32x32x16_bf16 v[96:111], a[56:59], a[220:223], v[96:111]
    ds_read_b128 a[80:83], v28 offset:28672
    ds_read_b128 a[84:87], v28 offset:29696
    s_add_u32 s56, s98, s83
    s_add_u32 s98, s3, 6
    s_cmp_ge_u32 s98, 7
    s_cselect_b32 s99, 7, 0
    s_waitcnt lgkmcnt(15)
    v_mfma_f32_32x32x16_bf16 v[112:127], a[60:63], a[220:223], v[112:127]
    ds_read_b128 v[92:95], v11 offset:8192
    ds_read_b64_tr_b16 a[220:221], v13 offset:19456
    ds_read_b64_tr_b16 a[222:223], v13 offset:19968
    s_add_u32 m0, s6, 12288
    s_add_u32 s96, s66, 0
    buffer_load_dwordx4 v25, s[32:35], s96 offen offset:3072 lds
    s_add_u32 m0, s6, 16384
    s_add_u32 s96, s66, 57344
    s_waitcnt lgkmcnt(15)
    buffer_load_dwordx4 v22, s[32:35], s96 offen offset:0 lds
    s_waitcnt lgkmcnt(14)
    v_mfma_f32_32x32x16_bf16 v[96:111], a[64:67], a[224:227], v[96:111]
    ds_read_b128 a[88:91], v28 offset:30720
    ds_read_b128 a[92:95], v28 offset:31744
    s_sub_u32 s98, s98, s99
    s_waitcnt lgkmcnt(15)
    v_mfma_f32_32x32x16_bf16 v[112:127], a[68:71], a[224:227], v[112:127]
    ds_read_b64_tr_b16 a[224:225], v13 offset:20480
    ds_read_b64_tr_b16 a[226:227], v13 offset:20992
    s_waitcnt lgkmcnt(14)
    buffer_load_dwordx4 v23, s[32:35], s96 offen offset:1024 lds
    s_waitcnt lgkmcnt(9)
    buffer_load_dwordx4 v24, s[32:35], s96 offen offset:2048 lds
    v_mfma_f32_32x32x16_bf16 v[96:111], a[72:75], a[228:231], v[96:111]
    ds_read_b128 a[96:99], v28 offset:32768
    ds_read_b128 a[100:103], v28 offset:33792
    s_lshl_b32 s98, s98, 13
    s_add_u32 s57, s98, s83
    v_mfma_f32_32x32x16_bf16 v[112:127], a[76:79], a[228:231], v[112:127]
    ds_read_b64_tr_b16 a[228:229], v13 offset:21504
    ds_read_b64_tr_b16 a[230:231], v13 offset:22016
    s_add_u32 m0, s6, 8192
    s_waitcnt lgkmcnt(10)
    buffer_load_dwordx4 v16, s[24:27], s69 offen offset:0 lds
    buffer_load_dwordx4 v17, s[24:27], s69 offen offset:1024 lds
    v_mfma_f32_32x32x16_bf16 v[96:111], a[80:83], a[232:235], v[96:111]
    ds_read_b128 a[104:107], v28 offset:34816
    ds_read_b128 a[108:111], v28 offset:35840
    v_mfma_f32_32x32x16_bf16 v[112:127], a[84:87], a[232:235], v[112:127]
    ds_read_b64_tr_b16 a[232:233], v13 offset:22528
    ds_read_b64_tr_b16 a[234:235], v13 offset:23040
    buffer_load_dwordx4 v26, s[24:27], s69 offen offset:2048 lds
    buffer_load_dwordx4 v27, s[24:27], s69 offen offset:3072 lds
    s_waitcnt lgkmcnt(11)
    v_mfma_f32_32x32x16_bf16 v[96:111], a[88:91], a[236:239], v[96:111]
    ds_read_b128 a[112:115], v28 offset:36864
    ds_read_b128 a[116:119], v28 offset:37888
    s_waitcnt lgkmcnt(12)
    v_mfma_f32_32x32x16_bf16 v[112:127], a[92:95], a[236:239], v[112:127]
    ds_read_b64_tr_b16 a[236:237], v13 offset:23552
    ds_read_b64_tr_b16 a[238:239], v13 offset:24064
    s_add_u32 m0, s6, 16384
    s_add_u32 s96, s66, 57344
    buffer_load_dwordx4 v25, s[32:35], s96 offen offset:3072 lds
    s_add_u32 m0, s6, 20480
    s_add_u32 s96, s66, 114688
    s_waitcnt lgkmcnt(12)
    buffer_load_dwordx4 v22, s[32:35], s96 offen offset:0 lds
    s_waitcnt lgkmcnt(11)
    v_mfma_f32_32x32x16_bf16 v[96:111], a[96:99], a[240:243], v[96:111]
    ds_read_b128 a[120:123], v28 offset:38912
    ds_read_b128 a[124:127], v28 offset:39936
    s_waitcnt lgkmcnt(12)
    v_mfma_f32_32x32x16_bf16 v[112:127], a[100:103], a[240:243], v[112:127]
    ds_read_b64_tr_b16 a[240:241], v13 offset:0
    ds_read_b64_tr_b16 a[242:243], v13 offset:512
    s_waitcnt lgkmcnt(12)
    buffer_load_dwordx4 v23, s[32:35], s96 offen offset:1024 lds
    s_waitcnt lgkmcnt(8)
    buffer_load_dwordx4 v24, s[32:35], s96 offen offset:2048 lds
    v_mfma_f32_32x32x16_bf16 v[96:111], a[104:107], a[244:247], v[96:111]
    ds_read_b64_tr_b16 a[128:129], v162 offset:0
    ds_read_b64_tr_b16 a[130:131], v163 offset:512
    ds_read_b64_tr_b16 a[132:133], v164 offset:0
    ds_read_b64_tr_b16 a[134:135], v165 offset:512
    v_mfma_f32_32x32x16_bf16 v[112:127], a[108:111], a[244:247], v[112:127]
    ds_read_b64_tr_b16 a[244:245], v13 offset:1024
    ds_read_b64_tr_b16 a[246:247], v13 offset:1536
    s_waitcnt lgkmcnt(10)
    buffer_load_dwordx4 v25, s[32:35], s96 offen offset:3072 lds
    v_mfma_f32_32x32x16_bf16 v[96:111], a[112:115], a[248:251], v[96:111]
    ds_read_b64_tr_b16 a[136:137], v162 offset:4096
    ds_read_b64_tr_b16 a[138:139], v163 offset:4608
    ds_read_b64_tr_b16 a[140:141], v164 offset:4096
    ds_read_b64_tr_b16 a[142:143], v165 offset:4608
    v_mfma_f32_32x32x16_bf16 v[112:127], a[116:119], a[248:251], v[112:127]
    s_waitcnt vmcnt(13)
    ds_read_b128 v[224:227], v8 offset:4096
    ds_read_b64_tr_b16 a[248:249], v13 offset:2048
    ds_read_b64_tr_b16 a[250:251], v13 offset:2560
    s_add_u32 m0, s6, 0
    s_add_u32 s96, s66, 172032
    s_waitcnt lgkmcnt(13)
    buffer_load_dwordx4 v22, s[32:35], s96 offen offset:0 lds
    v_mfma_f32_32x32x16_bf16 v[96:111], a[120:123], a[252:255], v[96:111]
    ds_read_b64_tr_b16 a[144:145], v162 offset:8192
    ds_read_b64_tr_b16 a[146:147], v163 offset:8704
    ds_read_b64_tr_b16 a[148:149], v164 offset:8192
    ds_read_b64_tr_b16 a[150:151], v165 offset:8704
    v_mfma_f32_32x32x16_bf16 v[112:127], a[124:127], a[252:255], v[112:127]
    ds_read_b128 v[228:231], v9 offset:4096
    ds_read_b64_tr_b16 a[252:253], v13 offset:3072
    ds_read_b64_tr_b16 a[254:255], v13 offset:3584
    s_waitcnt lgkmcnt(14)
    buffer_load_dwordx4 v23, s[32:35], s96 offen offset:1024 lds
    v_mfma_f32_32x32x16_bf16 v[96:111], a[128:131], v[64:67], v[96:111]
    ds_read_b64_tr_b16 a[152:153], v162 offset:12288
    ds_read_b64_tr_b16 a[154:155], v163 offset:12800
    ds_read_b64_tr_b16 a[156:157], v164 offset:12288
    ds_read_b64_tr_b16 a[158:159], v165 offset:12800
    v_mfma_f32_32x32x16_bf16 v[112:127], a[132:135], v[64:67], v[112:127]
    ds_read_b128 v[232:235], v10 offset:4096
    s_waitcnt lgkmcnt(12)
    buffer_load_dwordx4 v24, s[32:35], s96 offen offset:2048 lds
    v_mfma_f32_32x32x16_bf16 v[96:111], a[136:139], v[68:71], v[96:111]
    ds_read_b64_tr_b16 a[160:161], v162 offset:2048
    ds_read_b64_tr_b16 a[162:163], v163 offset:2560
    ds_read_b64_tr_b16 a[164:165], v164 offset:2048
    ds_read_b64_tr_b16 a[166:167], v165 offset:2560
    v_mfma_f32_32x32x16_bf16 v[112:127], a[140:143], v[68:71], v[112:127]
    ds_read_b128 v[236:239], v11 offset:4096
    s_waitcnt lgkmcnt(10)
    buffer_load_dwordx4 v25, s[32:35], s96 offen offset:3072 lds
    v_mfma_f32_32x32x16_bf16 v[96:111], a[144:147], v[72:75], v[96:111]
    ds_read_b64_tr_b16 a[168:169], v162 offset:6144
    ds_read_b64_tr_b16 a[170:171], v163 offset:6656
    ds_read_b64_tr_b16 a[172:173], v164 offset:6144
    ds_read_b64_tr_b16 a[174:175], v165 offset:6656
    v_mfma_f32_32x32x16_bf16 v[112:127], a[148:151], v[72:75], v[112:127]
    s_waitcnt vmcnt(9)
    ds_read_b128 v[240:243], v8 offset:8192
    s_waitcnt lgkmcnt(13)
    v_mfma_f32_32x32x16_bf16 v[96:111], a[152:155], v[76:79], v[96:111]
    ds_read_b64_tr_b16 a[176:177], v162 offset:10240
    ds_read_b64_tr_b16 a[178:179], v163 offset:10752
    ds_read_b64_tr_b16 a[180:181], v164 offset:10240
    ds_read_b64_tr_b16 a[182:183], v165 offset:10752
    s_waitcnt lgkmcnt(15)
    v_mfma_f32_32x32x16_bf16 v[112:127], a[156:159], v[76:79], v[112:127]
    ds_read_b128 v[244:247], v9 offset:8192
    s_add_u32 m0, s6, 4096
    s_waitcnt lgkmcnt(10)
    buffer_load_dwordx4 v16, s[20:23], s70 offen offset:0 lds
    buffer_load_dwordx4 v17, s[20:23], s70 offen offset:1024 lds
    v_mfma_f32_32x32x16_bf16 v[96:111], a[160:163], v[80:83], v[96:111]
    ds_read_b64_tr_b16 a[184:185], v162 offset:14336
    ds_read_b64_tr_b16 a[186:187], v163 offset:14848
    ds_read_b64_tr_b16 a[188:189], v164 offset:14336
    ds_read_b64_tr_b16 a[190:191], v165 offset:14848
    v_mfma_f32_32x32x16_bf16 v[112:127], a[164:167], v[80:83], v[112:127]
    ds_read_b128 v[248:251], v10 offset:8192
    buffer_load_dwordx4 v26, s[20:23], s70 offen offset:2048 lds
    buffer_load_dwordx4 v27, s[20:23], s70 offen offset:3072 lds
    s_waitcnt lgkmcnt(13)
    v_mfma_f32_32x32x16_bf16 v[96:111], a[168:171], v[84:87], v[96:111]
    ds_read_b128 v[252:255], v11 offset:8192
    s_waitcnt lgkmcnt(12)
    v_mfma_f32_32x32x16_bf16 v[112:127], a[172:175], v[84:87], v[112:127]
    s_waitcnt lgkmcnt(9)
    v_mfma_f32_32x32x16_bf16 v[96:111], a[176:179], v[88:91], v[96:111]
    s_waitcnt lgkmcnt(7)
    v_mfma_f32_32x32x16_bf16 v[112:127], a[180:183], v[88:91], v[112:127]
    s_waitcnt lgkmcnt(4)
    v_mfma_f32_32x32x16_bf16 v[96:111], a[184:187], v[92:95], v[96:111]
    s_waitcnt lgkmcnt(2)
    v_mfma_f32_32x32x16_bf16 v[112:127], a[188:191], v[92:95], v[112:127]
    s_add_u32 m0, s6, 8192
    s_waitcnt lgkmcnt(0)
    buffer_load_dwordx4 v16, s[24:27], s70 offen offset:0 lds
    buffer_load_dwordx4 v17, s[24:27], s70 offen offset:1024 lds
    v_mfma_f32_32x32x16_bf16 v[128:143], a[0:3], a[192:195], 0
    v_mfma_f32_32x32x16_bf16 v[144:159], a[4:7], a[192:195], 0
    ds_read_b64_tr_b16 a[192:193], v13 offset:12288
    ds_read_b64_tr_b16 a[194:195], v13 offset:12800
    buffer_load_dwordx4 v26, s[24:27], s70 offen offset:2048 lds
    v_mfma_f32_32x32x16_bf16 v[128:143], a[8:11], a[196:199], v[128:143]
    v_cvt_pk_bf16_f32 v192, v96, v97
    v_cvt_pk_bf16_f32 v193, v98, v99
    v_cvt_pk_bf16_f32 v194, v100, v101
    v_cvt_pk_bf16_f32 v195, v102, v103
    v_cvt_pk_bf16_f32 v196, v104, v105
    v_mfma_f32_32x32x16_bf16 v[144:159], a[12:15], a[196:199], v[144:159]
    ds_read_b64_tr_b16 a[196:197], v13 offset:13312
    ds_read_b64_tr_b16 a[198:199], v13 offset:13824
    buffer_load_dwordx4 v27, s[24:27], s70 offen offset:3072 lds
    v_cvt_pk_bf16_f32 v197, v106, v107
    v_cvt_pk_bf16_f32 v198, v108, v109
    v_mfma_f32_32x32x16_bf16 v[128:143], a[16:19], a[200:203], v[128:143]
    v_cvt_pk_bf16_f32 v199, v110, v111
    v_cvt_pk_bf16_f32 v200, v112, v113
    v_cvt_pk_bf16_f32 v201, v114, v115
    v_cvt_pk_bf16_f32 v202, v116, v117
    v_cvt_pk_bf16_f32 v203, v118, v119
    v_mfma_f32_32x32x16_bf16 v[144:159], a[20:23], a[200:203], v[144:159]
    ds_read_b64_tr_b16 a[200:201], v13 offset:14336
    ds_read_b64_tr_b16 a[202:203], v13 offset:14848
    s_add_u32 m0, s6, 12288
    s_add_u32 s96, s67, 0
    s_waitcnt lgkmcnt(4)
    buffer_load_dwordx4 v22, s[32:35], s96 offen offset:0 lds
    v_mfma_f32_32x32x16_bf16 v[128:143], a[24:27], a[204:207], v[128:143]
    v_cvt_pk_bf16_f32 v204, v120, v121
    v_cvt_pk_bf16_f32 v205, v122, v123
    v_cvt_pk_bf16_f32 v206, v124, v125
    v_cvt_pk_bf16_f32 v207, v126, v127
    v_mfma_f32_32x32x16_bf16 v[144:159], a[28:31], a[204:207], v[144:159]
    ds_read_b64_tr_b16 a[204:205], v13 offset:15360
    ds_read_b64_tr_b16 a[206:207], v13 offset:15872
    s_waitcnt lgkmcnt(4)
    buffer_load_dwordx4 v23, s[32:35], s96 offen offset:1024 lds
    v_mfma_f32_32x32x16_bf16 v[128:143], a[32:35], a[208:211], v[128:143]
    buffer_store_dwordx4 v[192:195], v28, s[36:39], s72 offen offset:0 sc1
    v_mfma_f32_32x32x16_bf16 v[144:159], a[36:39], a[208:211], v[144:159]
    ds_read_b64_tr_b16 a[208:209], v13 offset:16384
    ds_read_b64_tr_b16 a[210:211], v13 offset:16896
    buffer_store_dwordx4 v[196:199], v28, s[36:39], s72 offen offset:1024 sc1
    v_mfma_f32_32x32x16_bf16 v[128:143], a[40:43], a[212:215], v[128:143]
    buffer_store_dwordx4 v[200:203], v28, s[36:39], s72 offen offset:2048 sc1
    v_mfma_f32_32x32x16_bf16 v[144:159], a[44:47], a[212:215], v[144:159]
    ds_read_b64_tr_b16 a[212:213], v13 offset:17408
    ds_read_b64_tr_b16 a[214:215], v13 offset:17920
    buffer_store_dwordx4 v[204:207], v28, s[36:39], s72 offen offset:3072 sc1
    v_mfma_f32_32x32x16_bf16 v[128:143], a[48:51], a[216:219], v[128:143]
    v_mfma_f32_32x32x16_bf16 v[144:159], a[52:55], a[216:219], v[144:159]
    s_waitcnt vmcnt(22)
    ds_read_b64_tr_b16 a[216:217], v13 offset:18432
    ds_read_b64_tr_b16 a[218:219], v13 offset:18944
    v_mfma_f32_32x32x16_bf16 v[128:143], a[56:59], a[220:223], v[128:143]
    v_mfma_f32_32x32x16_bf16 v[144:159], a[60:63], a[220:223], v[144:159]
    ds_read_b64_tr_b16 a[220:221], v13 offset:19456
    ds_read_b64_tr_b16 a[222:223], v13 offset:19968
    v_mfma_f32_32x32x16_bf16 v[128:143], a[64:67], a[224:227], v[128:143]
    v_mfma_f32_32x32x16_bf16 v[144:159], a[68:71], a[224:227], v[144:159]
    s_waitcnt vmcnt(20)
    ds_read_b64_tr_b16 a[224:225], v13 offset:20480
    ds_read_b64_tr_b16 a[226:227], v13 offset:20992
    v_mfma_f32_32x32x16_bf16 v[128:143], a[72:75], a[228:231], v[128:143]
    v_mfma_f32_32x32x16_bf16 v[144:159], a[76:79], a[228:231], v[144:159]
    ds_read_b64_tr_b16 a[228:229], v13 offset:21504
    ds_read_b64_tr_b16 a[230:231], v13 offset:22016
    v_mfma_f32_32x32x16_bf16 v[128:143], a[80:83], a[232:235], v[128:143]
    v_mfma_f32_32x32x16_bf16 v[144:159], a[84:87], a[232:235], v[144:159]
    s_waitcnt vmcnt(18)
    ds_read_b64_tr_b16 a[232:233], v13 offset:22528
    ds_read_b64_tr_b16 a[234:235], v13 offset:23040
    v_mfma_f32_32x32x16_bf16 v[128:143], a[88:91], a[236:239], v[128:143]
    v_mfma_f32_32x32x16_bf16 v[144:159], a[92:95], a[236:239], v[144:159]
    ds_read_b64_tr_b16 a[236:237], v13 offset:23552
    ds_read_b64_tr_b16 a[238:239], v13 offset:24064
    s_waitcnt lgkmcnt(15)
    buffer_load_dwordx4 v24, s[32:35], s96 offen offset:2048 lds
    v_mfma_f32_32x32x16_bf16 v[128:143], a[96:99], a[240:243], v[128:143]
    s_waitcnt vmcnt(11)
    ds_read_b128 v[64:67], v8 offset:4096
    v_mfma_f32_32x32x16_bf16 v[144:159], a[100:103], a[240:243], v[144:159]
    ds_read_b64_tr_b16 a[240:241], v13 offset:0
    ds_read_b64_tr_b16 a[242:243], v13 offset:512
    buffer_load_dwordx4 v25, s[32:35], s96 offen offset:3072 lds
    v_mfma_f32_32x32x16_bf16 v[128:143], a[104:107], a[244:247], v[128:143]
    ds_read_b128 v[68:71], v9 offset:4096
    v_mfma_f32_32x32x16_bf16 v[144:159], a[108:111], a[244:247], v[144:159]
    ds_read_b64_tr_b16 a[244:245], v13 offset:1024
    ds_read_b64_tr_b16 a[246:247], v13 offset:1536
    s_add_u32 m0, s6, 16384
    s_add_u32 s96, s67, 57344
    s_waitcnt lgkmcnt(15)
    buffer_load_dwordx4 v22, s[32:35], s96 offen offset:0 lds
    v_mfma_f32_32x32x16_bf16 v[128:143], a[112:115], a[248:251], v[128:143]
    ds_read_b128 v[72:75], v10 offset:4096
    v_mfma_f32_32x32x16_bf16 v[144:159], a[116:119], a[248:251], v[144:159]
    ds_read_b64_tr_b16 a[248:249], v13 offset:2048
    ds_read_b64_tr_b16 a[250:251], v13 offset:2560
    buffer_load_dwordx4 v23, s[32:35], s96 offen offset:1024 lds
    v_mfma_f32_32x32x16_bf16 v[128:143], a[120:123], a[252:255], v[128:143]
    ds_read_b128 v[76:79], v11 offset:4096
    v_mfma_f32_32x32x16_bf16 v[144:159], a[124:127], a[252:255], v[144:159]
    ds_read_b64_tr_b16 a[252:253], v13 offset:3072
    ds_read_b64_tr_b16 a[254:255], v13 offset:3584
    buffer_load_dwordx4 v24, s[32:35], s96 offen offset:2048 lds
    v_mfma_f32_32x32x16_bf16 v[128:143], a[128:131], v[224:227], v[128:143]
    s_waitcnt vmcnt(11)
    ds_read_b128 v[80:83], v8 offset:8192
    v_mfma_f32_32x32x16_bf16 v[144:159], a[132:135], v[224:227], v[144:159]
    s_waitcnt lgkmcnt(15)
    buffer_load_dwordx4 v25, s[32:35], s96 offen offset:3072 lds
    v_mfma_f32_32x32x16_bf16 v[128:143], a[136:139], v[228:231], v[128:143]
    ds_read_b128 v[84:87], v9 offset:8192
    v_mfma_f32_32x32x16_bf16 v[144:159], a[140:143], v[228:231], v[144:159]
    s_add_u32 m0, s6, 20480
    s_nop 0
    buffer_load_dwordx4 v16, s[48:51], s71 offen offset:0 lds
    v_mfma_f32_32x32x16_bf16 v[128:143], a[144:147], v[232:235], v[128:143]
    ds_read_b128 v[88:91], v10 offset:8192
    v_mfma_f32_32x32x16_bf16 v[144:159], a[148:151], v[232:235], v[144:159]
    buffer_load_dwordx4 v17, s[48:51], s71 offen offset:1024 lds
    v_mfma_f32_32x32x16_bf16 v[128:143], a[152:155], v[236:239], v[128:143]
    ds_read_b128 v[92:95], v11 offset:8192
    v_mfma_f32_32x32x16_bf16 v[144:159], a[156:159], v[236:239], v[144:159]
    buffer_load_dwordx4 v26, s[48:51], s71 offen offset:2048 lds
    v_mfma_f32_32x32x16_bf16 v[128:143], a[160:163], v[240:243], v[128:143]
    v_mfma_f32_32x32x16_bf16 v[144:159], a[164:167], v[240:243], v[144:159]
    s_waitcnt lgkmcnt(15)
    buffer_load_dwordx4 v27, s[48:51], s71 offen offset:3072 lds
    v_mfma_f32_32x32x16_bf16 v[128:143], a[168:171], v[244:247], v[128:143]
    v_mfma_f32_32x32x16_bf16 v[144:159], a[172:175], v[244:247], v[144:159]
    v_mfma_f32_32x32x16_bf16 v[128:143], a[176:179], v[248:251], v[128:143]
    v_mfma_f32_32x32x16_bf16 v[144:159], a[180:183], v[248:251], v[144:159]
    v_mfma_f32_32x32x16_bf16 v[128:143], a[184:187], v[252:255], v[128:143]
    s_getreg_b32 s98, hwreg(HW_REG_IB_STS)
    s_and_b32 s98, s98, 0x00c0000f
    s_cmp_le_u32 s98, 10
    s_cselect_b32 s98, s90, s81
    s_cselect_b32 s90, s81, s90
    buffer_store_dword v221, v166, s[36:39], s98 offen sc1
    v_mfma_f32_32x32x16_bf16 v[144:159], a[188:191], v[252:255], v[144:159]
    v_mfma_f32_32x32x16_bf16 v[96:111], a[0:3], a[192:195], 0
    v_mfma_f32_32x32x16_bf16 v[96:111], a[8:11], a[196:199], v[96:111]
    v_mfma_f32_32x32x16_bf16 v[96:111], a[16:19], a[200:203], v[96:111]
    s_nop 1
    v_cvt_pk_bf16_f32 v192, v128, v129
    v_cvt_pk_bf16_f32 v193, v130, v131
    v_cvt_pk_bf16_f32 v194, v132, v133
    v_cvt_pk_bf16_f32 v195, v134, v135
    v_cvt_pk_bf16_f32 v196, v136, v137
    v_mfma_f32_32x32x16_bf16 v[96:111], a[24:27], a[204:207], v[96:111]
    v_cvt_pk_bf16_f32 v197, v138, v139
    v_cvt_pk_bf16_f32 v198, v140, v141
    v_cvt_pk_bf16_f32 v199, v142, v143
    v_cvt_pk_bf16_f32 v200, v144, v145
    v_cvt_pk_bf16_f32 v201, v146, v147
    v_mfma_f32_32x32x16_bf16 v[96:111], a[32:35], a[208:211], v[96:111]
    v_cvt_pk_bf16_f32 v202, v148, v149
    v_cvt_pk_bf16_f32 v203, v150, v151
    v_cvt_pk_bf16_f32 v204, v152, v153
    v_cvt_pk_bf16_f32 v205, v154, v155
    v_cvt_pk_bf16_f32 v206, v156, v157
    v_mfma_f32_32x32x16_bf16 v[96:111], a[40:43], a[212:215], v[96:111]
    v_cvt_pk_bf16_f32 v207, v158, v159
    buffer_store_dwordx4 v[192:195], v28, s[36:39], s73 offen offset:0 sc1
    buffer_store_dwordx4 v[196:199], v28, s[36:39], s73 offen offset:1024 sc1
    buffer_store_dwordx4 v[200:203], v28, s[36:39], s73 offen offset:2048 sc1
    buffer_store_dwordx4 v[204:207], v28, s[36:39], s73 offen offset:3072 sc1
    v_mfma_f32_32x32x16_bf16 v[96:111], a[48:51], a[216:219], v[96:111]
    ds_read_b128 v[224:227], v172 offset:0
    ds_read_b128 v[240:243], v172 offset:256
    ds_read_b128 v[228:231], v172 offset:16
    ds_read_b128 v[244:247], v172 offset:272
    ds_read_b128 v[232:235], v172 offset:32
    v_mfma_f32_32x32x16_bf16 v[96:111], a[56:59], a[220:223], v[96:111]
    ds_read_b128 v[248:251], v172 offset:288
    ds_read_b128 v[236:239], v172 offset:48
    ds_read_b128 v[252:255], v172 offset:304
    ds_read_b64_tr_b16 v[208:209], v173 offset:0
    ds_read_b64_tr_b16 v[210:211], v174 offset:1024
    ds_read_b64_tr_b16 v[212:213], v173 offset:2048
    v_mfma_f32_32x32x16_bf16 v[96:111], a[64:67], a[224:227], v[96:111]
    ds_read_b64_tr_b16 v[214:215], v174 offset:3072
    v_mfma_f32_32x32x16_bf16 v[96:111], a[72:75], a[228:231], v[96:111]
    v_mfma_f32_32x32x16_bf16 v[96:111], a[80:83], a[232:235], v[96:111]
    s_getreg_b32 s98, hwreg(HW_REG_IB_STS)
    s_and_b32 s98, s98, 0x00c0000f
    s_cmp_le_u32 s98, 15
    s_cselect_b32 s98, s90, s81
    s_cselect_b32 s90, s81, s90
    buffer_store_dword v221, v166, s[36:39], s98 offen sc1
    v_mfma_f32_32x32x16_bf16 v[96:111], a[88:91], a[236:239], v[96:111]
    s_waitcnt lgkmcnt(15)
    v_mfma_f32_32x32x16_bf16 v[96:111], a[96:99], a[240:243], v[96:111]
    v_mfma_f32_32x32x16_bf16 v[96:111], a[104:107], a[244:247], v[96:111]
    v_mfma_f32_32x32x16_bf16 v[96:111], a[112:115], a[248:251], v[96:111]
    v_mfma_f32_32x32x16_bf16 v[96:111], a[120:123], a[252:255], v[96:111]
    s_waitcnt lgkmcnt(10)
    v_mul_f32 v176, v240, v220
    v_mul_f32 v224, v224, v219
    v_mul_f32 v177, v241, v220
    v_mul_f32 v225, v225, v219
    v_mul_f32 v178, v242, v220
    v_mfma_f32_32x32x16_bf16 v[96:111], a[128:131], v[64:67], v[96:111]
    v_mul_f32 v226, v226, v219
    v_mul_f32 v179, v243, v220
    v_mul_f32 v227, v227, v219
    s_waitcnt lgkmcnt(8)
    v_mul_f32 v180, v244, v220
    v_mul_f32 v228, v228, v219
    v_mfma_f32_32x32x16_bf16 v[96:111], a[136:139], v[68:71], v[96:111]
    v_mul_f32 v181, v245, v220
    v_mul_f32 v229, v229, v219
    v_mul_f32 v182, v246, v220
    v_mul_f32 v230, v230, v219
    v_mul_f32 v183, v247, v220
    v_mfma_f32_32x32x16_bf16 v[96:111], a[144:147], v[72:75], v[96:111]
    v_mul_f32 v231, v231, v219
    s_waitcnt lgkmcnt(6)
    v_mul_f32 v184, v248, v220
    v_mul_f32 v232, v232, v219
    v_mul_f32 v185, v249, v220
    v_mul_f32 v233, v233, v219
    v_mfma_f32_32x32x16_bf16 v[96:111], a[152:155], v[76:79], v[96:111]
    v_mul_f32 v186, v250, v220
    v_mul_f32 v234, v234, v219
    v_mul_f32 v187, v251, v220
    v_mul_f32 v235, v235, v219
    s_waitcnt lgkmcnt(4)
    v_mul_f32 v188, v252, v220
    v_mfma_f32_32x32x16_bf16 v[96:111], a[160:163], v[80:83], v[96:111]
    v_mul_f32 v236, v236, v219
    v_mul_f32 v189, v253, v220
    v_mul_f32 v237, v237, v219
    v_mul_f32 v190, v254, v220
    v_mul_f32 v238, v238, v219
    v_mul_f32 v191, v255, v220
    v_mfma_f32_32x32x16_bf16 v[96:111], a[168:171], v[84:87], v[96:111]
    v_mul_f32 v239, v239, v219
    v_mfma_f32_32x32x16_bf16 v[96:111], a[176:179], v[88:91], v[96:111]
    s_getreg_b32 s98, hwreg(HW_REG_IB_STS)
    s_and_b32 s98, s98, 0x00c0000f
    s_cmp_le_u32 s98, 4194304
    s_cselect_b32 s98, s90, s81
    s_cselect_b32 s90, s81, s90
    buffer_store_dword v221, v166, s[36:39], s98 offen sc1
    v_mfma_f32_32x32x16_bf16 v[96:111], a[184:187], v[92:95], v[96:111]
    v_mfma_f32_32x32x16_bf16 v[112:127], a[4:7], a[192:195], 0
    s_waitcnt lgkmcnt(3)
    v_lshlrev_b32 v240, 16, v208
    v_fmac_f32 v176, v224, v240
    v_and_b32 v241, 0xffff0000, v208
    v_fmac_f32 v177, v225, v241
    v_lshlrev_b32 v242, 16, v209
    v_mfma_f32_32x32x16_bf16 v[112:127], a[12:15], a[196:199], v[112:127]
    v_fmac_f32 v178, v226, v242
    v_and_b32 v243, 0xffff0000, v209
    v_fmac_f32 v179, v227, v243
    s_waitcnt lgkmcnt(2)
    v_lshlrev_b32 v244, 16, v210
    v_fmac_f32 v180, v228, v244
    v_mfma_f32_32x32x16_bf16 v[112:127], a[20:23], a[200:203], v[112:127]
    v_cvt_pk_bf16_f32 v192, v96, v97
    v_cvt_pk_bf16_f32 v193, v98, v99
    v_cvt_pk_bf16_f32 v194, v100, v101
    v_cvt_pk_bf16_f32 v195, v102, v103
    v_cvt_pk_bf16_f32 v196, v104, v105
    v_mfma_f32_32x32x16_bf16 v[112:127], a[28:31], a[204:207], v[112:127]
    v_cvt_pk_bf16_f32 v197, v106, v107
    v_cvt_pk_bf16_f32 v198, v108, v109
    v_cvt_pk_bf16_f32 v199, v110, v111
    buffer_store_dwordx4 v[192:195], v28, s[36:39], s74 offen offset:0 sc1
    v_mfma_f32_32x32x16_bf16 v[112:127], a[36:39], a[208:211], v[112:127]
    v_mfma_f32_32x32x16_bf16 v[112:127], a[44:47], a[212:215], v[112:127]
    buffer_store_dwordx4 v[196:199], v28, s[36:39], s74 offen offset:1024 sc1
    v_mfma_f32_32x32x16_bf16 v[112:127], a[52:55], a[216:219], v[112:127]
    v_mfma_f32_32x32x16_bf16 v[112:127], a[60:63], a[220:223], v[112:127]
    v_mfma_f32_32x32x16_bf16 v[112:127], a[68:71], a[224:227], v[112:127]
    v_mfma_f32_32x32x16_bf16 v[112:127], a[76:79], a[228:231], v[112:127]
    v_mfma_f32_32x32x16_bf16 v[112:127], a[84:87], a[232:235], v[112:127]
    v_and_b32 v245, 0xffff0000, v210
    v_fmac_f32 v181, v229, v245
    v_lshlrev_b32 v246, 16, v211
    v_fmac_f32 v182, v230, v246
    v_and_b32 v247, 0xffff0000, v211
    v_mfma_f32_32x32x16_bf16 v[112:127], a[92:95], a[236:239], v[112:127]
    v_fmac_f32 v183, v231, v247
    s_waitcnt lgkmcnt(1)
    v_lshlrev_b32 v248, 16, v212
    v_fmac_f32 v184, v232, v248
    v_and_b32 v249, 0xffff0000, v212
    v_fmac_f32 v185, v233, v249
    v_mfma_f32_32x32x16_bf16 v[112:127], a[100:103], a[240:243], v[112:127]
    v_lshlrev_b32 v250, 16, v213
    v_fmac_f32 v186, v234, v250
    v_and_b32 v251, 0xffff0000, v213
    v_fmac_f32 v187, v235, v251
    s_waitcnt lgkmcnt(0)
    v_lshlrev_b32 v252, 16, v214
    v_mfma_f32_32x32x16_bf16 v[112:127], a[108:111], a[244:247], v[112:127]
    v_fmac_f32 v188, v236, v252
    v_and_b32 v253, 0xffff0000, v214
    v_fmac_f32 v189, v237, v253
    v_lshlrev_b32 v254, 16, v215
    v_fmac_f32 v190, v238, v254
    v_mfma_f32_32x32x16_bf16 v[112:127], a[116:119], a[248:251], v[112:127]
    v_and_b32 v255, 0xffff0000, v215
    v_fmac_f32 v191, v239, v255
    s_getreg_b32 s98, hwreg(HW_REG_IB_STS)
    s_and_b32 s98, s98, 0x00c0000f
    s_cmp_le_u32 s98, 4
    s_cselect_b32 s98, s91, s81
    s_cselect_b32 s91, s81, s91
    buffer_store_dword v221, v166, s[36:39], s98 offen sc1
    v_mfma_f32_32x32x16_bf16 v[112:127], a[124:127], a[252:255], v[112:127]
    v_mfma_f32_32x32x16_bf16 v[112:127], a[132:135], v[64:67], v[112:127]
    s_getreg_b32 s98, hwreg(HW_REG_IB_STS)
    s_and_b32 s98, s98, 0x00c0000f
    s_cmp_le_u32 s98, 5
    s_cselect_b32 s98, s91, s81
    s_cselect_b32 s91, s81, s91
    buffer_store_dword v221, v166, s[36:39], s98 offen sc1
    v_mfma_f32_32x32x16_bf16 v[112:127], a[140:143], v[68:71], v[112:127]
    v_mfma_f32_32x32x16_bf16 v[112:127], a[148:151], v[72:75], v[112:127]
    v_mfma_f32_32x32x16_bf16 v[112:127], a[156:159], v[76:79], v[112:127]
    v_mfma_f32_32x32x16_bf16 v[112:127], a[164:167], v[80:83], v[112:127]
    v_mfma_f32_32x32x16_bf16 v[112:127], a[172:175], v[84:87], v[112:127]
    v_mfma_f32_32x32x16_bf16 v[112:127], a[180:183], v[88:91], v[112:127]
    s_getreg_b32 s98, hwreg(HW_REG_IB_STS)
    s_and_b32 s98, s98, 0x00c0000f
    s_cmp_le_u32 s98, 6
    s_cselect_b32 s98, s91, s81
    s_cselect_b32 s91, s81, s91
    buffer_store_dword v221, v166, s[36:39], s98 offen sc1
    v_mfma_f32_32x32x16_bf16 v[112:127], a[188:191], v[92:95], v[112:127]
    s_and_b32 s98, s5, 1
    s_mul_i32 s98, s98, 24576
    s_add_u32 s98, s98, 69632
    s_sub_u32 s98, s98, s6
    v_add_u32 v13, s98, v13
    v_add_u32 v8, s98, v8
    v_add_u32 v9, s98, v9
    v_add_u32 v10, s98, v10
    v_add_u32 v11, s98, v11
    s_mov_b32 s79, 0
    s_waitcnt vmcnt(12)
    s_barrier
    ds_read_b64_tr_b16 v[48:49], v13 offset:0
    ds_read_b64_tr_b16 v[50:51], v13 offset:512
    ds_read_b64_tr_b16 v[52:53], v13 offset:1024
    ds_read_b64_tr_b16 v[54:55], v13 offset:1536
    ds_read_b64_tr_b16 v[56:57], v13 offset:2048
    ds_read_b64_tr_b16 v[58:59], v13 offset:2560
    s_cmp_lt_u32 s5, 2
    s_cbranch_scc0 L_D1
    s_waitcnt lgkmcnt(4)
    v_mfma_f32_32x32x16_bf16 v[128:143], a[0:3], v[48:51], v[176:191]
    ds_read_b64_tr_b16 v[60:61], v13 offset:3072
    ds_read_b64_tr_b16 v[62:63], v13 offset:3584
    v_cvt_pk_bf16_f32 v200, v112, v113
    v_cvt_pk_bf16_f32 v201, v114, v115
    v_cvt_pk_bf16_f32 v202, v116, v117
    s_waitcnt lgkmcnt(4)
    v_mfma_f32_32x32x16_bf16 v[128:143], a[8:11], v[52:55], v[128:143]
    ds_read_b64_tr_b16 v[48:49], v13 offset:4096
    ds_read_b64_tr_b16 v[50:51], v13 offset:4608
    v_cvt_pk_bf16_f32 v203, v118, v119
    buffer_store_dwordx4 v[200:203], v28, s[36:39], s74 offen offset:2048 sc1
    v_cvt_pk_bf16_f32 v204, v120, v121
    s_waitcnt lgkmcnt(4)
    v_mfma_f32_32x32x16_bf16 v[128:143], a[16:19], v[56:59], v[128:143]
    ds_read_b64_tr_b16 v[52:53], v13 offset:5120
    ds_read_b64_tr_b16 v[54:55], v13 offset:5632
    v_cvt_pk_bf16_f32 v205, v122, v123
    v_cvt_pk_bf16_f32 v206, v124, v125
    v_cvt_pk_bf16_f32 v207, v126, v127
    s_waitcnt lgkmcnt(4)
    v_mfma_f32_32x32x16_bf16 v[128:143], a[24:27], v[60:63], v[128:143]
    ds_read_b64_tr_b16 v[56:57], v13 offset:6144
    ds_read_b64_tr_b16 v[58:59], v13 offset:6656
    buffer_store_dwordx4 v[204:207], v28, s[36:39], s74 offen offset:3072 sc1
    s_waitcnt lgkmcnt(4)
    v_mfma_f32_32x32x16_bf16 v[128:143], a[32:35], v[48:51], v[128:143]
    ds_read_b64_tr_b16 v[60:61], v13 offset:7168
    ds_read_b64_tr_b16 v[62:63], v13 offset:7680
    s_waitcnt lgkmcnt(4)
    v_mfma_f32_32x32x16_bf16 v[128:143], a[40:43], v[52:55], v[128:143]
    ds_read_b64_tr_b16 v[48:49], v13 offset:49152
    ds_read_b64_tr_b16 v[50:51], v13 offset:49664
    s_waitcnt lgkmcnt(4)
    v_mfma_f32_32x32x16_bf16 v[128:143], a[48:51], v[56:59], v[128:143]
    ds_read_b64_tr_b16 v[52:53], v13 offset:50176
    ds_read_b64_tr_b16 v[54:55], v13 offset:50688
    s_getreg_b32 s98, hwreg(HW_REG_IB_STS)
    s_and_b32 s98, s98, 0x00c0000f
    s_cmp_le_u32 s98, 9
    s_cselect_b32 s98, s91, s81
    s_cselect_b32 s91, s81, s91
    buffer_store_dword v221, v166, s[36:39], s98 offen sc1
    s_waitcnt lgkmcnt(4)
    v_mfma_f32_32x32x16_bf16 v[128:143], a[56:59], v[60:63], v[128:143]
    ds_read_b64_tr_b16 v[56:57], v13 offset:51200
    ds_read_b64_tr_b16 v[58:59], v13 offset:51712
    s_waitcnt lgkmcnt(4)
    v_mfma_f32_32x32x16_bf16 v[128:143], a[64:67], v[48:51], v[128:143]
    ds_read_b64_tr_b16 v[60:61], v13 offset:52224
    ds_read_b64_tr_b16 v[62:63], v13 offset:52736
    s_waitcnt lgkmcnt(4)
    v_mfma_f32_32x32x16_bf16 v[128:143], a[72:75], v[52:55], v[128:143]
    ds_read_b64_tr_b16 v[48:49], v13 offset:53248
    ds_read_b64_tr_b16 v[50:51], v13 offset:53760
    s_waitcnt lgkmcnt(4)
    v_mfma_f32_32x32x16_bf16 v[128:143], a[80:83], v[56:59], v[128:143]
    ds_read_b64_tr_b16 v[52:53], v13 offset:54272
    ds_read_b64_tr_b16 v[54:55], v13 offset:54784
    s_waitcnt lgkmcnt(4)
    v_mfma_f32_32x32x16_bf16 v[128:143], a[88:91], v[60:63], v[128:143]
    ds_read_b64_tr_b16 v[56:57], v13 offset:55296
    ds_read_b64_tr_b16 v[58:59], v13 offset:55808
    s_waitcnt lgkmcnt(4)
    v_mfma_f32_32x32x16_bf16 v[128:143], a[96:99], v[48:51], v[128:143]
    ds_read_b64_tr_b16 v[60:61], v13 offset:56320
    ds_read_b64_tr_b16 v[62:63], v13 offset:56832
    s_waitcnt lgkmcnt(4)
    v_mfma_f32_32x32x16_bf16 v[128:143], a[104:107], v[52:55], v[128:143]
    ds_read_b128 v[48:51], v8 offset:8192
    s_waitcnt lgkmcnt(3)
    v_mfma_f32_32x32x16_bf16 v[128:143], a[112:115], v[56:59], v[128:143]
    ds_read_b128 v[52:55], v9 offset:8192
    s_getreg_b32 s98, hwreg(HW_REG_IB_STS)
    s_and_b32 s98, s98, 0x00c0000f
    s_cmp_le_u32 s98, 10
    s_cselect_b32 s98, s91, s81
    s_cselect_b32 s91, s81, s91
    buffer_store_dword v221, v166, s[36:39], s98 offen sc1
    s_waitcnt lgkmcnt(2)
    v_mfma_f32_32x32x16_bf16 v[128:143], a[120:123], v[60:63], v[128:143]
    ds_read_b128 v[56:59], v10 offset:8192
    s_waitcnt lgkmcnt(2)
    v_mfma_f32_32x32x16_bf16 v[128:143], a[128:131], v[48:51], v[128:143]
    ds_read_b128 v[60:63], v11 offset:8192
    buffer_load_dword v208, v167, s[36:39], s93 offen sc1
    s_waitcnt lgkmcnt(2)
    v_mfma_f32_32x32x16_bf16 v[128:143], a[136:139], v[52:55], v[128:143]
    ds_read_b128 v[48:51], v8 offset:57344
    s_waitcnt lgkmcnt(2)
    v_mfma_f32_32x32x16_bf16 v[128:143], a[144:147], v[56:59], v[128:143]
    ds_read_b128 v[52:55], v9 offset:57344
    s_getreg_b32 s98, hwreg(HW_REG_IB_STS)
    s_and_b32 s98, s98, 0x00c0000f
    s_cmp_le_u32 s98, 3
    s_cselect_b32 s98, s92, s81
    s_cselect_b32 s92, s81, s92
    buffer_store_dword v221, v166, s[36:39], s98 offen sc1
    s_waitcnt lgkmcnt(2)
    v_mfma_f32_32x32x16_bf16 v[128:143], a[152:155], v[60:63], v[128:143]
    ds_read_b128 v[56:59], v10 offset:57344
    s_waitcnt lgkmcnt(2)
    v_mfma_f32_32x32x16_bf16 v[128:143], a[160:163], v[48:51], v[128:143]
    ds_read_b128 v[60:63], v11 offset:57344
    s_waitcnt lgkmcnt(2)
    v_mfma_f32_32x32x16_bf16 v[128:143], a[168:171], v[52:55], v[128:143]
    s_waitcnt lgkmcnt(1)
    v_mfma_f32_32x32x16_bf16 v[128:143], a[176:179], v[56:59], v[128:143]
    s_waitcnt lgkmcnt(0)
    v_mfma_f32_32x32x16_bf16 v[128:143], a[184:187], v[60:63], v[128:143]
    s_getreg_b32 s98, hwreg(HW_REG_IB_STS)
    s_and_b32 s98, s98, 0x00c0000f
    s_cmp_le_u32 s98, 4
    s_cselect_b32 s98, s92, s81
    s_cselect_b32 s92, s81, s92
    buffer_store_dword v221, v166, s[36:39], s98 offen sc1
    s_branch L_Dend
L_D1:
    s_waitcnt lgkmcnt(4)
    v_mfma_f32_32x32x16_bf16 v[128:143], a[4:7], v[48:51], v[176:191]
    ds_read_b64_tr_b16 v[60:61], v13 offset:3072
    ds_read_b64_tr_b16 v[62:63], v13 offset:3584
    v_cvt_pk_bf16_f32 v200, v112, v113
    v_cvt_pk_bf16_f32 v201, v114, v115
    v_cvt_pk_bf16_f32 v202, v116, v117
    s_waitcnt lgkmcnt(4)
    v_mfma_f32_32x32x16_bf16 v[128:143], a[12:15], v[52:55], v[128:143]
    ds_read_b64_tr_b16 v[48:49], v13 offset:4096
    ds_read_b64_tr_b16 v[50:51], v13 offset:4608
    v_cvt_pk_bf16_f32 v203, v118, v119
    buffer_store_dwordx4 v[200:203], v28, s[36:39], s74 offen offset:2048 sc1
    v_cvt_pk_bf16_f32 v204, v120, v121
    s_waitcnt lgkmcnt(4)
    v_mfma_f32_32x32x16_bf16 v[128:143], a[20:23], v[56:59], v[128:143]
    ds_read_b64_tr_b16 v[52:53], v13 offset:5120
    ds_read_b64_tr_b16 v[54:55], v13 offset:5632
    v_cvt_pk_bf16_f32 v205, v122, v123
    v_cvt_pk_bf16_f32 v206, v124, v125
    v_cvt_pk_bf16_f32 v207, v126, v127
    s_waitcnt lgkmcnt(4)
    v_mfma_f32_32x32x16_bf16 v[128:143], a[28:31], v[60:63], v[128:143]
    ds_read_b64_tr_b16 v[56:57], v13 offset:6144
    ds_read_b64_tr_b16 v[58:59], v13 offset:6656
    buffer_store_dwordx4 v[204:207], v28, s[36:39], s74 offen offset:3072 sc1
    s_waitcnt lgkmcnt(4)
    v_mfma_f32_32x32x16_bf16 v[128:143], a[36:39], v[48:51], v[128:143]
    ds_read_b64_tr_b16 v[60:61], v13 offset:7168
    ds_read_b64_tr_b16 v[62:63], v13 offset:7680
    s_waitcnt lgkmcnt(4)
    v_mfma_f32_32x32x16_bf16 v[128:143], a[44:47], v[52:55], v[128:143]
    ds_read_b64_tr_b16 v[48:49], v13 offset:49152
    ds_read_b64_tr_b16 v[50:51], v13 offset:49664
    s_waitcnt lgkmcnt(4)
    v_mfma_f32_32x32x16_bf16 v[128:143], a[52:55], v[56:59], v[128:143]
    ds_read_b64_tr_b16 v[52:53], v13 offset:50176
    ds_read_b64_tr_b16 v[54:55], v13 offset:50688
    s_getreg_b32 s98, hwreg(HW_REG_IB_STS)
    s_and_b32 s98, s98, 0x00c0000f
    s_cmp_le_u32 s98, 9
    s_cselect_b32 s98, s91, s81
    s_cselect_b32 s91, s81, s91
    buffer_store_dword v221, v166, s[36:39], s98 offen sc1
    s_waitcnt lgkmcnt(4)
    v_mfma_f32_32x32x16_bf16 v[128:143], a[60:63], v[60:63], v[128:143]
    ds_read_b64_tr_b16 v[56:57], v13 offset:51200
    ds_read_b64_tr_b16 v[58:59], v13 offset:51712
    s_waitcnt lgkmcnt(4)
    v_mfma_f32_32x32x16_bf16 v[128:143], a[68:71], v[48:51], v[128:143]
    ds_read_b64_tr_b16 v[60:61], v13 offset:52224
    ds_read_b64_tr_b16 v[62:63], v13 offset:52736
    s_waitcnt lgkmcnt(4)
    v_mfma_f32_32x32x16_bf16 v[128:143], a[76:79], v[52:55], v[128:143]
    ds_read_b64_tr_b16 v[48:49], v13 offset:53248
    ds_read_b64_tr_b16 v[50:51], v13 offset:53760
    s_waitcnt lgkmcnt(4)
    v_mfma_f32_32x32x16_bf16 v[128:143], a[84:87], v[56:59], v[128:143]
    ds_read_b64_tr_b16 v[52:53], v13 offset:54272
    ds_read_b64_tr_b16 v[54:55], v13 offset:54784
    s_waitcnt lgkmcnt(4)
    v_mfma_f32_32x32x16_bf16 v[128:143], a[92:95], v[60:63], v[128:143]
    ds_read_b64_tr_b16 v[56:57], v13 offset:55296
    ds_read_b64_tr_b16 v[58:59], v13 offset:55808
    s_waitcnt lgkmcnt(4)
    v_mfma_f32_32x32x16_bf16 v[128:143], a[100:103], v[48:51], v[128:143]
    ds_read_b64_tr_b16 v[60:61], v13 offset:56320
    ds_read_b64_tr_b16 v[62:63], v13 offset:56832
    s_waitcnt lgkmcnt(4)
    v_mfma_f32_32x32x16_bf16 v[128:143], a[108:111], v[52:55], v[128:143]
    ds_read_b128 v[48:51], v8 offset:8192
    s_waitcnt lgkmcnt(3)
    v_mfma_f32_32x32x16_bf16 v[128:143], a[116:119], v[56:59], v[128:143]
    ds_read_b128 v[52:55], v9 offset:8192
    s_getreg_b32 s98, hwreg(HW_REG_IB_STS)
    s_and_b32 s98, s98, 0x00c0000f
    s_cmp_le_u32 s98, 10
    s_cselect_b32 s98, s91, s81
    s_cselect_b32 s91, s81, s91
    buffer_store_dword v221, v166, s[36:39], s98 offen sc1
    s_waitcnt lgkmcnt(2)
    v_mfma_f32_32x32x16_bf16 v[128:143], a[124:127], v[60:63], v[128:143]
    ds_read_b128 v[56:59], v10 offset:8192
    s_waitcnt lgkmcnt(2)
    v_mfma_f32_32x32x16_bf16 v[128:143], a[132:135], v[48:51], v[128:143]
    ds_read_b128 v[60:63], v11 offset:8192
    buffer_load_dword v208, v167, s[36:39], s93 offen sc1
    s_waitcnt lgkmcnt(2)
    v_mfma_f32_32x32x16_bf16 v[128:143], a[140:143], v[52:55], v[128:143]
    ds_read_b128 v[48:51], v8 offset:57344
    s_waitcnt lgkmcnt(2)
    v_mfma_f32_32x32x16_bf16 v[128:143], a[148:151], v[56:59], v[128:143]
    ds_read_b128 v[52:55], v9 offset:57344
    s_getreg_b32 s98, hwreg(HW_REG_IB_STS)
    s_and_b32 s98, s98, 0x00c0000f
    s_cmp_le_u32 s98, 3
    s_cselect_b32 s98, s92, s81
    s_cselect_b32 s92, s81, s92
    buffer_store_dword v221, v166, s[36:39], s98 offen sc1
    s_waitcnt lgkmcnt(2)
    v_mfma_f32_32x32x16_bf16 v[128:143], a[156:159], v[60:63], v[128:143]
    ds_read_b128 v[56:59], v10 offset:57344
    s_waitcnt lgkmcnt(2)
    v_mfma_f32_32x32x16_bf16 v[128:143], a[164:167], v[48:51], v[128:143]
    ds_read_b128 v[60:63], v11 offset:57344
    s_waitcnt lgkmcnt(2)
    v_mfma_f32_32x32x16_bf16 v[128:143], a[172:175], v[52:55], v[128:143]
    s_waitcnt lgkmcnt(1)
    v_mfma_f32_32x32x16_bf16 v[128:143], a[180:183], v[56:59], v[128:143]
    s_waitcnt lgkmcnt(0)
    v_mfma_f32_32x32x16_bf16 v[128:143], a[188:191], v[60:63], v[128:143]
    s_getreg_b32 s98, hwreg(HW_REG_IB_STS)
    s_and_b32 s98, s98, 0x00c0000f
    s_cmp_le_u32 s98, 4
    s_cselect_b32 s98, s92, s81
    s_cselect_b32 s92, s81, s92
    buffer_store_dword v221, v166, s[36:39], s98 offen sc1
    s_nop 0
L_Dend:
    s_lshl_b32 s96, s4, 2
    s_lshr_b32 s97, s5, 1
    s_add_u32 s96, s96, s97
    s_mulk_i32 s96, 28672
    s_lshl_b32 s97, s3, 1
    s_and_b32 s98, s5, 1
    s_add_u32 s97, s97, s98
    s_lshl_b32 s97, s97, 7
    s_add_u32 s96, s96, s97
    buffer_store_dword v221, v166, s[36:39], s90 offen sc1
    s_waitcnt vmcnt(15)
    buffer_store_dword v221, v166, s[36:39], s91 offen sc1
    s_waitcnt vmcnt(7)
    buffer_store_dword v221, v166, s[36:39], s92 offen sc1
    s_waitcnt vmcnt(5)
    v_cmp_ne_u32 vcc, s7, v208
    s_nop 3
    s_and_b32 vcc_lo, vcc_lo, 60
    s_cbranch_scc1 L_pollB
L_pollB_ok:
    buffer_load_dwordx4 v[232:235], v28, s[36:39], s57 offen sc1
    buffer_load_dwordx4 v[236:239], v28, s[36:39], s57 offen offset:1024 sc1
    buffer_load_dwordx4 v[224:227], v28, s[36:39], s56 offen sc1
    buffer_load_dwordx4 v[228:231], v28, s[36:39], s56 offen offset:1024 sc1
    buffer_load_dwordx4 v[88:91], v28, s[36:39], s55 offen sc1
    buffer_load_dwordx4 v[92:95], v28, s[36:39], s55 offen offset:1024 sc1
    buffer_load_dwordx4 v[80:83], v28, s[36:39], s54 offen sc1
    buffer_load_dwordx4 v[84:87], v28, s[36:39], s54 offen offset:1024 sc1
    v_cmp_ne_u32 vcc, s7, v208
    s_nop 3
    s_and_b32 vcc_lo, vcc_lo, 3
    s_cbranch_scc1 L_pollC
L_pollC_ok:
    buffer_load_dwordx4 v[72:75], v28, s[36:39], s53 offen sc1
    buffer_load_dwordx4 v[76:79], v28, s[36:39], s53 offen offset:1024 sc1
    buffer_load_dwordx4 v[64:67], v28, s[36:39], s52 offen sc1
    buffer_load_dwordx4 v[68:71], v28, s[36:39], s52 offen offset:1024 sc1
    s_waitcnt vmcnt(11)
    v_dot2_f32_bf16 v128, v232, s77, v128
    v_dot2_f32_bf16 v129, v232, s78, v129
    v_dot2_f32_bf16 v130, v233, s77, v130
    v_dot2_f32_bf16 v131, v233, s78, v131
    v_dot2_f32_bf16 v132, v234, s77, v132
    v_dot2_f32_bf16 v133, v234, s78, v133
    v_dot2_f32_bf16 v134, v235, s77, v134
    v_dot2_f32_bf16 v135, v235, s78, v135
    s_waitcnt vmcnt(10)
    v_dot2_f32_bf16 v136, v236, s77, v136
    v_dot2_f32_bf16 v137, v236, s78, v137
    v_dot2_f32_bf16 v138, v237, s77, v138
    v_dot2_f32_bf16 v139, v237, s78, v139
    v_dot2_f32_bf16 v140, v238, s77, v140
    v_dot2_f32_bf16 v141, v238, s78, v141
    v_dot2_f32_bf16 v142, v239, s77, v142
    v_dot2_f32_bf16 v143, v239, s78, v143
    s_waitcnt vmcnt(9)
    v_dot2_f32_bf16 v128, v224, s77, v128
    v_dot2_f32_bf16 v129, v224, s78, v129
    v_dot2_f32_bf16 v130, v225, s77, v130
    v_dot2_f32_bf16 v131, v225, s78, v131
    v_dot2_f32_bf16 v132, v226, s77, v132
    v_dot2_f32_bf16 v133, v226, s78, v133
    v_dot2_f32_bf16 v134, v227, s77, v134
    v_dot2_f32_bf16 v135, v227, s78, v135
    s_waitcnt vmcnt(8)
    v_dot2_f32_bf16 v136, v228, s77, v136
    v_dot2_f32_bf16 v137, v228, s78, v137
    v_dot2_f32_bf16 v138, v229, s77, v138
    v_dot2_f32_bf16 v139, v229, s78, v139
    v_dot2_f32_bf16 v140, v230, s77, v140
    v_dot2_f32_bf16 v141, v230, s78, v141
    v_dot2_f32_bf16 v142, v231, s77, v142
    v_dot2_f32_bf16 v143, v231, s78, v143
    s_waitcnt vmcnt(7)
    v_dot2_f32_bf16 v128, v88, s77, v128
    v_dot2_f32_bf16 v129, v88, s78, v129
    v_dot2_f32_bf16 v130, v89, s77, v130
    v_dot2_f32_bf16 v131, v89, s78, v131
    v_dot2_f32_bf16 v132, v90, s77, v132
    v_dot2_f32_bf16 v133, v90, s78, v133
    v_dot2_f32_bf16 v134, v91, s77, v134
    v_dot2_f32_bf16 v135, v91, s78, v135
    s_waitcnt vmcnt(6)
    v_dot2_f32_bf16 v136, v92, s77, v136
    v_dot2_f32_bf16 v137, v92, s78, v137
    v_dot2_f32_bf16 v138, v93, s77, v138
    v_dot2_f32_bf16 v139, v93, s78, v139
    v_dot2_f32_bf16 v140, v94, s77, v140
    v_dot2_f32_bf16 v141, v94, s78, v141
    v_dot2_f32_bf16 v142, v95, s77, v142
    v_dot2_f32_bf16 v143, v95, s78, v143
    s_waitcnt vmcnt(5)
    v_dot2_f32_bf16 v128, v80, s77, v128
    v_dot2_f32_bf16 v129, v80, s78, v129
    v_dot2_f32_bf16 v130, v81, s77, v130
    v_dot2_f32_bf16 v131, v81, s78, v131
    v_dot2_f32_bf16 v132, v82, s77, v132
    v_dot2_f32_bf16 v133, v82, s78, v133
    v_dot2_f32_bf16 v134, v83, s77, v134
    v_dot2_f32_bf16 v135, v83, s78, v135
    s_waitcnt vmcnt(4)
    v_dot2_f32_bf16 v136, v84, s77, v136
    v_dot2_f32_bf16 v137, v84, s78, v137
    v_dot2_f32_bf16 v138, v85, s77, v138
    v_dot2_f32_bf16 v139, v85, s78, v139
    v_dot2_f32_bf16 v140, v86, s77, v140
    v_dot2_f32_bf16 v141, v86, s78, v141
    v_dot2_f32_bf16 v142, v87, s77, v142
    v_dot2_f32_bf16 v143, v87, s78, v143
    s_waitcnt vmcnt(3)
    v_dot2_f32_bf16 v128, v72, s77, v128
    v_dot2_f32_bf16 v129, v72, s78, v129
    v_dot2_f32_bf16 v130, v73, s77, v130
    v_dot2_f32_bf16 v131, v73, s78, v131
    v_dot2_f32_bf16 v132, v74, s77, v132
    v_dot2_f32_bf16 v133, v74, s78, v133
    v_dot2_f32_bf16 v134, v75, s77, v134
    v_dot2_f32_bf16 v135, v75, s78, v135
    s_waitcnt vmcnt(2)
    v_dot2_f32_bf16 v136, v76, s77, v136
    v_dot2_f32_bf16 v137, v76, s78, v137
    v_dot2_f32_bf16 v138, v77, s77, v138
    v_dot2_f32_bf16 v139, v77, s78, v139
    v_dot2_f32_bf16 v140, v78, s77, v140
    v_dot2_f32_bf16 v141, v78, s78, v141
    v_dot2_f32_bf16 v142, v79, s77, v142
    v_dot2_f32_bf16 v143, v79, s78, v143
    s_waitcnt vmcnt(1)
    v_dot2_f32_bf16 v128, v64, s77, v128
    v_dot2_f32_bf16 v129, v64, s78, v129
    v_dot2_f32_bf16 v130, v65, s77, v130
    v_dot2_f32_bf16 v131, v65, s78, v131
    v_dot2_f32_bf16 v132, v66, s77, v132
    v_dot2_f32_bf16 v133, v66, s78, v133
    buffer_store_dword v128, v223, s[40:43], s96 offen sc1
    buffer_store_dword v129, v223, s[40:43], s96 offen offset:1792 sc1
    s_add_u32 s96, s96, 3584
    v_dot2_f32_bf16 v134, v67, s77, v134
    v_dot2_f32_bf16 v135, v67, s78, v135
    buffer_store_dword v130, v223, s[40:43], s96 offen sc1
    buffer_store_dword v131, v223, s[40:43], s96 offen offset:1792 sc1
    s_add_u32 s96, s96, 3584
    s_waitcnt vmcnt(4)
    v_dot2_f32_bf16 v136, v68, s77, v136
    v_dot2_f32_bf16 v137, v68, s78, v137
    buffer_store_dword v132, v223, s[40:43], s96 offen sc1
    buffer_store_dword v133, v223, s[40:43], s96 offen offset:1792 sc1
    s_add_u32 s96, s96, 3584
    v_dot2_f32_bf16 v138, v69, s77, v138
    v_dot2_f32_bf16 v139, v69, s78, v139
    buffer_store_dword v134, v223, s[40:43], s96 offen sc1
    buffer_store_dword v135, v223, s[40:43], s96 offen offset:1792 sc1
    s_add_u32 s96, s96, 3584
    v_dot2_f32_bf16 v140, v70, s77, v140
    v_dot2_f32_bf16 v141, v70, s78, v141
    buffer_store_dword v136, v223, s[40:43], s96 offen sc1
    buffer_store_dword v137, v223, s[40:43], s96 offen offset:1792 sc1
    s_add_u32 s96, s96, 3584
    v_dot2_f32_bf16 v142, v71, s77, v142
    v_dot2_f32_bf16 v143, v71, s78, v143
    buffer_store_dword v138, v223, s[40:43], s96 offen sc1
    buffer_store_dword v139, v223, s[40:43], s96 offen offset:1792 sc1
    s_add_u32 s96, s96, 3584
    buffer_store_dword v140, v223, s[40:43], s96 offen sc1
    buffer_store_dword v141, v223, s[40:43], s96 offen offset:1792 sc1
    s_add_u32 s96, s96, 3584
    buffer_store_dword v142, v223, s[40:43], s96 offen sc1
    buffer_store_dword v143, v223, s[40:43], s96 offen offset:1792 sc1
    s_add_u32 s96, s96, 3584
    s_cmp_eq_u32 s4, 31
    s_cbranch_scc0 L_noepoch
    s_or_b32 s98, s3, s5
    s_cbranch_scc1 L_noepoch
    buffer_store_dword v221, v166, s[36:39], 0 offen sc1
L_noepoch:
L_end:
    s_endpgm
L_lb_retry:
    s_mov_b32 s79, 0
    s_branch L_lb_first
L_lb_again:
L_lb_first:
    buffer_load_dwordx4 v[224:227], v2, s[44:47], 0 offen offset:0 sc1
    buffer_load_dwordx4 v[228:231], v2, s[44:47], 0 offen offset:256 sc1
    buffer_load_dwordx4 v[232:235], v2, s[44:47], 0 offen offset:512 sc1
    buffer_load_dwordx4 v[236:239], v2, s[44:47], 0 offen offset:768 sc1
    buffer_load_dwordx4 v[240:243], v2, s[44:47], 0 offen offset:1024 sc1
    buffer_load_dwordx4 v[244:247], v2, s[44:47], 0 offen offset:1280 sc1
    buffer_load_dwordx4 v[248:251], v2, s[44:47], 0 offen offset:1536 sc1
    buffer_load_dwordx4 v[252:255], v2, s[44:47], 0 offen offset:1792 sc1
    s_waitcnt vmcnt(0)
    v_bitop3_b32 v213, v225, v227, s7 bitop3:0x7e
    v_min_u32 v212, 1, v213
    v_bitop3_b32 v213, v229, v231, s7 bitop3:0x7e
    v_min_u32 v213, 1, v213
    v_lshl_or_b32 v212, v212, 1, v213
    v_bitop3_b32 v213, v233, v235, s7 bitop3:0x7e
    v_min_u32 v213, 1, v213
    v_lshl_or_b32 v212, v212, 1, v213
    v_bitop3_b32 v213, v237, v239, s7 bitop3:0x7e
    v_min_u32 v213, 1, v213
    v_lshl_or_b32 v212, v212, 1, v213
    v_bitop3_b32 v213, v241, v243, s7 bitop3:0x7e
    v_min_u32 v213, 1, v213
    v_lshl_or_b32 v212, v212, 1, v213
    v_bitop3_b32 v213, v245, v247, s7 bitop3:0x7e
    v_min_u32 v213, 1, v213
    v_lshl_or_b32 v212, v212, 1, v213
    v_bitop3_b32 v213, v249, v251, s7 bitop3:0x7e
    v_min_u32 v213, 1, v213
    v_lshl_or_b32 v212, v212, 1, v213
    v_bitop3_b32 v213, v253, v255, s7 bitop3:0x7e
    v_min_u32 v213, 1, v213
    v_lshl_or_b32 v212, v212, 1, v213
    v_and_b32 v212, v212, v3
    v_cmp_ne_u32 vcc, 0, v212
    s_add_u32 s79, s79, 1
    s_cmp_gt_u32 s79, 0x40000
    s_cbranch_scc1 L_lb_ok
    s_nop 2
    s_cbranch_vccnz L_lb_again
    s_branch L_lb_ok
L_pollB:
    buffer_load_dword v208, v167, s[36:39], s93 offen sc1
    s_add_u32 s79, s79, 1
    s_cmp_gt_u32 s79, 0x40000
    s_waitcnt vmcnt(0)
    s_cbranch_scc1 L_pollB_ok
    v_cmp_ne_u32 vcc, s7, v208
    s_nop 3
    s_and_b32 vcc_lo, vcc_lo, 60
    s_cbranch_scc1 L_pollB
    s_branch L_pollB_ok
L_pollC:
    buffer_load_dword v208, v167, s[36:39], s93 offen sc1
    s_add_u32 s79, s79, 1
    s_cmp_gt_u32 s79, 0x40000
    s_waitcnt vmcnt(0)
    s_cbranch_scc1 L_pollC_ok
    v_cmp_ne_u32 vcc, s7, v208
    s_nop 3
    s_and_b32 vcc_lo, vcc_lo, 3
    s_cbranch_scc1 L_pollC
    s_branch L_pollC_ok
L_helper:
    s_bitcmp1_b32 s2, 0
    s_cselect_b32 s4, 3, 0
    s_sub_u32 s26, s96, s98
    s_lshl_b32 s26, s26, 2
    s_add_u32 s26, s26, s5
    s_sub_u32 s27, 32, s98
    s_lshl_b32 s27, s27, 2
    s_add_u32 s46, s26, s27
    s_cmp_ge_u32 s26, 16
    s_cbranch_scc1 L_end
    v_mul_u32_u24 v4, 896, v1
    v_lshrrev_b32 v5, 4, v1
    v_lshl_add_u32 v5, v5, 29, v4
    s_mov_b32 s10, 1605632
    s_mov_b32 s11, 0x20000
    s_mov_b32 s14, 401408
    s_mov_b32 s15, 0x20000
    s_mov_b32 s18, 401408
    s_mov_b32 s19, 0x20000
    s_mov_b32 s30, 1605632
    s_mov_b32 s31, 0x20000
    s_mov_b32 s34, 401408
    s_mov_b32 s35, 0x20000
    v_lshrrev_b32 v6, 1, v1
    v_and_b32 v7, 1, v1
    v_lshlrev_b32 v7, 8, v7
    v_min_u32 v8, 27, v6
    v_mul_u32_u24 v6, 3584, v6
    v_mul_u32_u24 v8, 3584, v8
    v_add_u32 v6, v6, v7
    v_add_u32 v8, v8, v7
    v_min_u32 v7, 55, v1
    v_lshlrev_b32 v7, 7, v7
    s_lshr_b32 s23, s26, 2
    s_add_u32 s23, s23, s4
    s_and_b32 s24, s26, 3
    s_lshl_b32 s20, s23, 2
    s_add_u32 s20, s20, s24
    s_mul_i32 s20, s20, 57344
    s_mul_i32 s21, s24, 14336
    s_lshl_b32 s22, s23, 7
    s_add_u32 s21, s21, s22
    s_mul_i32 s24, s24, 401408
    s_lshl_b32 s22, s23, 9
    s_add_u32 s24, s24, s22
    s_add_u32 s24, s24, 128
    s_cmp_lt_u32 s26, 16
    s_cselect_b32 s25, 0, 0x40000000
    s_add_u32 s20, s20, s25
    s_add_u32 s21, s21, s25
    s_add_u32 s24, s24, s25
    s_waitcnt lgkmcnt(0)
    s_mov_b64 s[8:9], s[88:89]
    s_mov_b64 s[12:13], s[74:75]
    s_mov_b64 s[16:17], s[76:77]
    s_mov_b64 s[28:29], s[84:85]
    s_bitcmp1_b32 s26, 3
    s_cselect_b64 s[32:33], s[72:73], s[70:71]
    s_and_b32 s48, s26, 7
    s_mul_i32 s48, s48, 7168
    s_add_u32 s48, s48, 172032
    s_add_u32 s48, s48, s25
    buffer_load_dword v9, v7, s[32:35], s48 offen
    s_mul_i32 s48, s26, 100352
    s_add_u32 s48, s48, 1536
    s_add_u32 s48, s48, s25
    buffer_load_dword v10, v8, s[28:31], s48 offen
    buffer_load_dword v11, v6, s[28:31], s24 offen
    s_add_u32 s24, s24, 114688
    buffer_load_dword v12, v6, s[28:31], s24 offen
    s_add_u32 s24, s24, 114688
    buffer_load_dword v13, v6, s[28:31], s24 offen
    s_add_u32 s24, s24, 57344
    buffer_load_dword v14, v6, s[28:31], s24 offen
    s_add_u32 s24, s24, 57344
    s_add_u32 s23, s23, 1
    s_cmp_ge_u32 s23, 7
    s_cselect_b32 s23, 0, s23
    s_lshl_b32 s48, s23, 7
    s_add_u32 s48, s48, s20
    s_mul_i32 s49, s23, 57344
    s_add_u32 s49, s49, s21
    buffer_load_dword v15, v4, s[8:11], s48 offen
    buffer_load_dword v16, v5, s[12:15], s49 offen
    buffer_load_dword v17, v5, s[16:19], s49 offen
    s_add_u32 s23, s23, 1
    s_cmp_ge_u32 s23, 7
    s_cselect_b32 s23, 0, s23
    s_lshl_b32 s48, s23, 7
    s_add_u32 s48, s48, s20
    s_mul_i32 s49, s23, 57344
    s_add_u32 s49, s49, s21
    buffer_load_dword v18, v4, s[8:11], s48 offen
    buffer_load_dword v19, v5, s[12:15], s49 offen
    buffer_load_dword v20, v5, s[16:19], s49 offen
    s_add_u32 s23, s23, 1
    s_cmp_ge_u32 s23, 7
    s_cselect_b32 s23, 0, s23
    s_lshl_b32 s48, s23, 7
    s_add_u32 s48, s48, s20
    s_mul_i32 s49, s23, 57344
    s_add_u32 s49, s49, s21
    buffer_load_dword v21, v4, s[8:11], s48 offen
    buffer_load_dword v22, v5, s[12:15], s49 offen
    buffer_load_dword v23, v5, s[16:19], s49 offen
    s_add_u32 s23, s23, 1
    s_cmp_ge_u32 s23, 7
    s_cselect_b32 s23, 0, s23
    s_lshl_b32 s48, s23, 7
    s_add_u32 s48, s48, s20
    s_mul_i32 s49, s23, 57344
    s_add_u32 s49, s49, s21
    buffer_load_dword v24, v4, s[8:11], s48 offen
    buffer_load_dword v25, v5, s[12:15], s49 offen
    buffer_load_dword v26, v5, s[16:19], s49 offen
    s_add_u32 s23, s23, 1
    s_cmp_ge_u32 s23, 7
    s_cselect_b32 s23, 0, s23
    s_lshl_b32 s48, s23, 7
    s_add_u32 s48, s48, s20
    s_mul_i32 s49, s23, 57344
    s_add_u32 s49, s49, s21
    buffer_load_dword v27, v4, s[8:11], s48 offen
    buffer_load_dword v28, v5, s[12:15], s49 offen
    buffer_load_dword v29, v5, s[16:19], s49 offen
    s_add_u32 s23, s23, 1
    s_cmp_ge_u32 s23, 7
    s_cselect_b32 s23, 0, s23
    s_lshl_b32 s48, s23, 7
    s_add_u32 s48, s48, s20
    s_mul_i32 s49, s23, 57344
    s_add_u32 s49, s49, s21
    buffer_load_dword v30, v4, s[8:11], s48 offen
    buffer_load_dword v31, v5, s[12:15], s49 offen
    buffer_load_dword v32, v5, s[16:19], s49 offen
    s_add_u32 s23, s23, 1
    s_cmp_ge_u32 s23, 7
    s_cselect_b32 s23, 0, s23
    s_lshl_b32 s48, s23, 7
    s_add_u32 s48, s48, s20
    s_mul_i32 s49, s23, 57344
    s_add_u32 s49, s49, s21
    buffer_load_dword v33, v4, s[8:11], s48 offen
    buffer_load_dword v34, v5, s[12:15], s49 offen
    buffer_load_dword v35, v5, s[16:19], s49 offen
    s_waitcnt vmcnt(0)
    s_endpgm
L_codeend:
.section .rodata,"a"
.p2align 6
.amdhsa_kernel gated_mix__ssm_conv_s5__dense_activation_gelu__prompt_kernel
  .amdhsa_next_free_vgpr 512
  .amdhsa_next_free_sgpr 102
  .amdhsa_accum_offset 256
  .amdhsa_group_segment_fixed_size 0
  .amdhsa_kernarg_size 144
  .amdhsa_user_sgpr_count 2
  .amdhsa_user_sgpr_kernarg_segment_ptr 1
  .amdhsa_system_sgpr_workgroup_id_x 1
.end_amdhsa_kernel
```
